```python
import torch

def _softmax(x, axis=-1):
    return torch.softmax(x, dim=axis)

def _gelu(x):
    return torch.nn.functional.gelu(x, approximate='tanh')

def _silu(x):
    return torch.nn.functional.silu(x)

def _sigmoid(x):
    return torch.sigmoid(x)

def _layernorm(x, axis=-1, eps=1e-05):
    m = x.mean(dim=axis, keepdim=True)
    v = x.var(dim=axis, keepdim=True, unbiased=False)
    return (x - m) / torch.sqrt(v + eps)

def _scatter_add(tgt, idx, src, axis=0):
    return tgt.clone().index_add_(axis, idx, src)

def _segment_sum(src, seg, n):
    out = torch.zeros((n,) + src.shape[1:], dtype=src.dtype)
    return out.index_add_(0, seg, src)

def _pad(x, pw):
    flat = tuple((v for pair in reversed(pw) for v in pair))
    return torch.nn.functional.pad(x, flat)
kernel_name = 'adaLN_cond__spectral_gfnet__dense_activation_silu__prompt'

def setup_inputs():

    _w = lambda a: (lambda t: t.to(torch.bfloat16) if t.is_floating_point() else t)(torch.as_tensor(a))

    def _A_setup():
        B, S, D = (1, 2048, 448)
        Df = D // 2 + 1
        return {'x': _w((lambda *s: torch.randn(*s, dtype=torch.bfloat16) * 0.05)(B, S, D)), 'w_r': _w((lambda *s: torch.randn(*s, dtype=torch.bfloat16) * 1.6)(S, Df) * 0.02), 'w_i': _w((lambda *s: torch.randn(*s, dtype=torch.bfloat16) * 1.6)(S, Df) * 0.02)}
    _A_in = _A_setup()

    def _B_setup():
        B, S, D, F = (1, 2048, 448, 1792)
        return {'x': _w((lambda *s: torch.randn(*s, dtype=torch.bfloat16) * 0.05)(B, S, D)), 'w1': _w((lambda *s: torch.randn(*s, dtype=torch.bfloat16) * 0.8)(D, F) * D ** (-0.5)), 'w2': _w((lambda *s: torch.randn(*s, dtype=torch.bfloat16) * 0.2)(F, D) * F ** (-0.5))}
    _B_in = _B_setup()
    return {'A_x': _A_in['x'], 'A_w_r': _A_in['w_r'], 'A_w_i': _A_in['w_i'], 'B_x': _B_in['x'], 'B_w1': _B_in['w1'], 'B_w2': _B_in['w2'], 'c': _w((lambda *s: torch.randn(*s, dtype=torch.bfloat16) * 0.2)(1, 448) * 8.0), 'w_mod': _w((lambda *s: torch.randn(*s, dtype=torch.bfloat16) * 0.2)(448, 6 * 448) * 448 ** (-0.5) * 8.0)}

def reference(A_x, A_w_r, A_w_i, B_x, B_w1, B_w2, c, w_mod):

    def _A_ref(x, w_r, w_i):
        B, S, D = x.shape
        X = (lambda x, axes=(-2, -1): torch.fft.rfft2(x.float(), dim=axes))(x, axes=(-2, -1))
        W = w_r + 1j * w_i
        X = X * W
        y = (lambda x, s, axes=(-2, -1): torch.fft.irfft2(x, s=s, dim=axes).to(torch.bfloat16))(X, (S, D), axes=(-2, -1))
        return y

    def _B_ref(x, w1, w2):
        h = torch.einsum('bsd,df->bsf', x, w1)
        h = _silu(h)
        out = torch.einsum('bsf,fd->bsd', h, w2)
        return out
    x = A_x
    mod = (_silu(c) @ w_mod).reshape(c.shape[0], 6, 1, -1)
    sa, ca, ga, sb, cb, gb = (mod[:, 0].clone(), mod[:, 1].clone(), mod[:, 2].clone(), mod[:, 3].clone(), mod[:, 4].clone(), mod[:, 5].clone())
    h = _layernorm(x, axis=-1) * (1 + ca) + sa
    x = x + ga * _A_ref(h, A_w_r, A_w_i)
    h = _layernorm(x, axis=-1) * (1 + cb) + sb
    x = x + gb * _B_ref(h, B_w1, B_w2)
    return x
```

```asm
; @launch grid=(256,1,1) block=(256,1,1) lds=158720
.amdgcn_target "amdgcn-amd-amdhsa--gfx950"
.text
.globl adaLN_cond__spectral_gfnet__dense_activation_silu__prompt_kernel
.p2align 8
.type adaLN_cond__spectral_gfnet__dense_activation_silu__prompt_kernel,@function
adaLN_cond__spectral_gfnet__dense_activation_silu__prompt_kernel:
    s_cmp_ge_u32 s2, 256
    s_cbranch_scc1 ad_rend_2
    s_load_dwordx8 s[8:15], s[0:1], 32
    s_load_dwordx4 s[4:7], s[0:1], 0
    s_load_dwordx2 s[20:21], s[0:1], 80
    s_load_dwordx2 s[16:17], s[0:1], 16
    s_load_dwordx2 s[18:19], s[0:1], 64
    s_getpc_b64 s[24:25]
ad_here_4:
    s_mov_b32 s26, ad_last_3-ad_here_4
    s_mov_b32 s27, 0x20000
    s_lshr_b32 s3, s2, 3
    s_lshl_b32 s3, s3, 10
    v_lshlrev_b32 v1, 2, v0
    buffer_load_dword a248, v1, s[24:27], s3 offen
    s_add_u32 s2, s2, 224
    s_and_b32 s2, s2, 255
    s_lshr_b32 s3, s2, 3
    s_lshl_b32 s3, s3, 1
    s_and_b32 s22, s2, 1
    s_add_u32 s3, s3, s22
    s_bfe_u32 s23, s2, 0x20001
    s_cmp_lt_u32 s23, 3
    s_cselect_b32 s3, s3, 56
    s_cmp_eq_u32 s23, 0
    s_cselect_b32 s24, 56, s3
    v_lshrrev_b32 v6, 6, v0
    v_and_b32 v1, 63, v0
    v_readfirstlane_b32 s22, v6
    v_and_b32 v2, 15, v0
    v_bfe_u32 v3, v0, 4, 2
    v_lshlrev_b32 v4, 4, v1
    v_lshlrev_b32 v5, 4, v0
    v_mov_b32 v8, 0x80000000
    s_add_u32 s30, s22, 1
    s_and_b32 s30, s30, 3
    s_mul_i32 s32, s3, 4682
    s_lshr_b32 s32, s32, 16
    s_mul_i32 s26, s32, 14
    s_sub_u32 s25, s3, s26
    s_mul_i32 s31, s32, 112
    s_lshl_b32 s26, s22, 5
    s_add_u32 s31, s31, s26
    s_mul_i32 s31, s31, 5376
    s_lshl_b32 s26, s25, 7
    s_add_u32 s31, s31, s26
    s_mul_i32 s33, s32, 3584
    s_lshl_b32 s25, s25, 2
    s_add_u32 s25, s25, s22
    s_lshl_b32 s25, s25, 6
    s_add_u32 s33, s33, s25
    s_add_u32 s33, s33, 0xa000
    s_mul_i32 s25, s23, 14336
    s_add_u32 s33, s33, s25
    s_mul_i32 s25, s23, 1792
    s_add_u32 s31, s31, s25
    s_cmp_eq_u32 s23, 0
    s_cselect_b32 s3, s3, 56
    s_mul_i32 s32, s32, 224
    v_lshrrev_b32 v6, 3, v1
    v_and_b32 v7, 7, v0
    v_mul_u32_u24 v13, 5376, v6
    v_lshl_add_u32 v13, v7, 4, v13
    v_lshlrev_b32 v16, 1, v0
    v_cmp_gt_u32 vcc, 112, v0
    s_nop 1
    v_cndmask_b32 v16, v8, v16, vcc
    s_lshr_b32 s34, s2, 7
    s_and_b32 s35, s2, 15
    s_lshr_b32 s36, s2, 4
    s_lshl_b32 s23, s35, 3
    s_and_b32 s25, s36, 7
    s_add_u32 s23, s23, s25
    v_cmp_gt_u32 s[38:39], 56, v1
    s_lshl_b32 s37, s22, 12
    s_waitcnt lgkmcnt(0)
    s_mov_b32 s40, s12
    s_mov_b32 s41, s13
    s_mov_b32 s42, 0x380
    s_mov_b32 s43, 0x20000
    s_mov_b32 s44, s14
    s_mov_b32 s45, s15
    s_mov_b32 s46, 0x24c000
    s_mov_b32 s47, 0x20000
    s_cmp_ge_u32 s3, 56
    s_cbranch_scc1 ad_nomod_5
    buffer_load_ushort v17, v16, s[40:43], s32 offen
    s_add_u32 m0, s37, 94208
    s_nop 0
    buffer_load_dwordx4 v13, s[44:47], s31 offen nt lds
    s_add_u32 s31, s31, 43008
    s_add_u32 m0, s37, 95232
    s_nop 0
    buffer_load_dwordx4 v13, s[44:47], s31 offen nt lds
    s_add_u32 s31, s31, 43008
    s_add_u32 m0, s37, 96256
    s_nop 0
    buffer_load_dwordx4 v13, s[44:47], s31 offen nt lds
    s_add_u32 s31, s31, 43008
    s_add_u32 m0, s37, 97280
    s_nop 0
    buffer_load_dwordx4 v13, s[44:47], s31 offen nt lds
    s_add_u32 s31, s31, 43008
ad_nomod_5:
    s_mov_b32 s48, s4
    s_mov_b32 s49, s5
    s_mov_b32 s50, 0x1c0000
    s_mov_b32 s51, 0x20000
    s_lshl_b32 s25, s22, 9
    s_add_u32 s25, s25, s23
    s_mul_i32 s25, s25, 896
    s_mul_i32 s26, s22, 3648
    s_mov_b64 exec, s[38:39]
    s_add_u32 m0, s26, 131072
    s_nop 0
    buffer_load_dwordx4 v4, s[48:51], s25 offen nt lds
    s_add_u32 s25, s25, 114688
    s_add_u32 m0, s26, 131984
    s_nop 0
    buffer_load_dwordx4 v4, s[48:51], s25 offen nt lds
    s_add_u32 s25, s25, 114688
    s_add_u32 m0, s26, 132896
    s_nop 0
    buffer_load_dwordx4 v4, s[48:51], s25 offen nt lds
    s_add_u32 s25, s25, 114688
    s_add_u32 m0, s26, 133808
    s_nop 0
    buffer_load_dwordx4 v4, s[48:51], s25 offen nt lds
    s_add_u32 s25, s25, 114688
    s_mov_b64 exec, -1
    s_load_dword s29, s[20:21], 0
    s_mov_b32 s52, s20
    s_mov_b32 s53, s21
    s_mov_b32 s54, 0xdb4000
    s_mov_b32 s55, 0x20000
    s_cmp_lt_u32 s2, 224
    s_cselect_b32 s58, 0xdb4000, 0
    s_cselect_b32 s62, 1605632, 0
    s_cselect_b32 s66, 1605632, 0
    s_mov_b32 s56, s52
    s_mov_b32 s57, s53
    s_mov_b32 s59, 0x20000
    s_mov_b32 s60, s8
    s_mov_b32 s61, s9
    s_mov_b32 s63, 0x20000
    s_mov_b32 s64, s10
    s_mov_b32 s65, s11
    s_mov_b32 s67, 0x20000
    v_bfe_u32 v18, v0, 3, 2
    v_bfe_u32 v7, v0, 5, 1
    v_lshl_add_u32 v6, v7, 3, v18
    v_mul_u32_u24 v7, 224, v7
    v_add_u32 v7, v18, v7
    v_mul_u32_u24 v19, 3584, v7
    v_sub_u32 v7, 343, v7
    v_mul_u32_u24 v20, 3584, v7
    v_mul_u32_u24 v18, 896, v6
    v_and_b32 v6, 7, v0
    v_lshl_add_u32 v18, v6, 4, v18
    v_lshl_add_u32 v19, v6, 4, v19
    v_lshl_add_u32 v20, v6, 4, v20
    s_lshl_b32 s25, s2, 2
    s_add_u32 s25, s25, s22
    s_mul_i32 s26, s25, 9363
    s_lshr_b32 s26, s26, 16
    s_mul_i32 s27, s26, 7
    s_sub_u32 s27, s25, s27
    s_mul_i32 s70, s27, 229376
    s_lshl_b32 s68, s26, 10
    s_add_u32 s70, s70, s68
    s_add_u32 s70, s70, 0xaa4000
    s_cmp_ge_u32 s25, 784
    s_cselect_b32 s70, 0x40000000, s70
    s_add_u32 s71, s70, 114688
    s_lshr_b32 s25, s26, 1
    s_mul_i32 s68, s25, 4682
    s_lshr_b32 s68, s68, 16
    s_mul_i32 s69, s68, 14
    s_sub_u32 s25, s25, s69
    s_lshl_b32 s25, s25, 2
    s_add_u32 s25, s25, s68
    s_lshl_b32 s25, s25, 1
    s_and_b32 s26, s26, 1
    s_add_u32 s25, s25, s26
    s_mul_i32 s25, s25, 14336
    s_lshl_b32 s27, s27, 7
    s_add_u32 s25, s25, s27
    s_mov_b32 s72, s25
    s_lshr_b32 s26, s22, 1
    s_mul_i32 s73, s26, 57344
    s_and_b32 s26, s22, 1
    s_lshl_b32 s26, s26, 11
    s_add_u32 s73, s73, s26
    s_add_u32 s73, s73, 53248
    s_cmp_gt_u32 s2, 224
    s_cselect_b32 s74, 224, 0
    s_sub_u32 s74, s2, s74
    s_and_b32 s75, s74, 15
    s_lshr_b32 s76, s74, 4
    s_mov_b32 s80, s6
    s_mov_b32 s81, s7
    s_mov_b32 s82, 0xe1000
    s_mov_b32 s83, 0x20000
    s_mov_b32 s84, s16
    s_mov_b32 s85, s17
    s_mov_b32 s86, 0xe1000
    s_mov_b32 s87, 0x20000
    s_cmp_ge_u32 s76, 7
    s_cselect_b32 s26, 223, 0
    s_lshl_b32 s25, s76, 5
    s_sub_u32 s25, s25, s26
    v_lshl_add_u32 v6, v2, 1, s25
    v_mov_b32 v22, 0x36124925
    v_mov_b32 v7, 0x35924925
    v_cmp_eq_u32 vcc, 0, v6
    s_cmp_eq_u32 s2, 224
    s_nop 2
    s_cselect_b64 vcc, -1, vcc
    v_cndmask_b32 v22, v22, v7, vcc
    s_mul_i32 s77, s75, 225
    s_add_u32 s77, s77, s25
    s_and_b32 s26, s77, 1
    s_sub_u32 s77, s77, s26
    s_lshl_b32 s77, s77, 1
    s_mul_i32 s25, s22, 115200
    s_add_u32 s77, s77, s25
    s_lshl_b32 s78, s22, 12
    s_add_u32 s78, s78, 36864
    s_lshl_b32 s26, s26, 1
    s_add_u32 s26, s26, s78
    v_lshlrev_b32 v23, 2, v2
    v_lshl_add_u32 v23, v3, 8, v23
    v_add_u32 v23, s26, v23
    v_lshrrev_b32 v6, 2, v1
    v_mul_u32_u24 v21, 7200, v6
    v_and_b32 v6, 3, v0
    v_lshl_add_u32 v21, v6, 4, v21
    v_lshlrev_b32 v24, 6, v2
    v_lshl_add_u32 v24, v3, 4, v24
    v_cmp_eq_u32 vcc, 0, v2
    s_nop 1
    v_cndmask_b32 v25, v8, v24, vcc
    s_mul_i32 s88, s34, 7
    s_add_u32 s88, s88, s30
    s_lshl_b32 s75, s88, 10
    s_mul_i32 s79, s23, 14464
    s_add_u32 s79, s79, 0x20000
    s_add_u32 s75, s75, s79
    s_add_u32 s79, s79, 14336
    s_add_u32 s76, s75, 3072
    s_cmp_eq_u32 s22, 3
    s_cselect_b32 s76, 0x40000000, s76
    v_mov_b32 v28, -1
    v_mov_b32 v29, -1
    v_mov_b32 v30, -1
    v_mov_b32 v31, -1
    s_cmp_lt_u32 s3, 56
    s_cbranch_scc1 ad_nofill_6
    buffer_store_dwordx4 v[28:31], v4, s[52:55], s75 offen sc1
    buffer_store_dwordx4 v[28:31], v4, s[52:55], s76 offen sc1
    s_cmp_eq_u32 s88, 0
    s_cselect_b32 s25, s79, 0x40000000
    buffer_store_dwordx4 v[28:31], v25, s[52:55], s25 offen sc1
ad_nofill_6:
    v_mul_u32_u24 v32, 450, v0
    v_cmp_gt_u32 vcc, 8, v0
    s_nop 1
    v_cndmask_b32 v32, v8, v32, vcc
    v_cvt_f32_u32 v9, v3
    s_lshl_b32 s89, s36, 1
    s_lshr_b32 s25, s22, 1
    s_add_u32 s89, s89, s25
    s_lshl_b32 s89, s89, 7
    s_mul_i32 s90, s25, 57344
    s_and_b32 s25, s22, 1
    s_lshl_b32 s26, s25, 10
    s_add_u32 s90, s90, s26
    s_mul_i32 s25, s25, 14336
    v_add_u32 v19, s25, v19
    v_subrev_u32 v20, s25, v20
    v_and_b32 v6, 16, v0
    v_lshlrev_b32 v6, 2, v6
    v_xor_b32 v19, v19, v6
    v_xor_b32 v20, v20, v6
    s_lshl_b32 s25, s30, 5
    s_add_u32 s25, s25, s34
    v_lshl_add_u32 v6, v2, 1, s25
    v_cvt_f32_u32 v33, v6
    v_mul_f32 v33, 0xba924925, v33
    v_add_f32 v42, v33, v33
    v_mul_f32 v6, 0x41800000, v9
    v_fma_f32 v43, v33, v6, v33
    v_cos_f32 v44, v42
    v_mul_f32 v48, 0x42000000, v42
    v_cos_f32 v46, v48
    v_add_f32 v44, v44, v44
    v_add_f32 v46, v46, v46
    v_cos_f32 v184, v43
    v_sin_f32 v185, v43
    v_fmamk_f32 v48, v42, 0x3f800000, v43
    v_cos_f32 v186, v48
    v_sin_f32 v187, v48
    s_nop 0
    v_pk_fma_f32 v[188:189], v[44:45], v[186:187], v[184:185] op_sel_hi:[0,1,1] neg_lo:[0,0,1] neg_hi:[0,0,1]
    v_pk_fma_f32 v[190:191], v[44:45], v[188:189], v[186:187] op_sel_hi:[0,1,1] neg_lo:[0,0,1] neg_hi:[0,0,1]
    v_pk_fma_f32 v[192:193], v[44:45], v[190:191], v[188:189] op_sel_hi:[0,1,1] neg_lo:[0,0,1] neg_hi:[0,0,1]
    v_pk_fma_f32 v[194:195], v[44:45], v[192:193], v[190:191] op_sel_hi:[0,1,1] neg_lo:[0,0,1] neg_hi:[0,0,1]
    v_pk_fma_f32 v[196:197], v[44:45], v[194:195], v[192:193] op_sel_hi:[0,1,1] neg_lo:[0,0,1] neg_hi:[0,0,1]
    v_pk_fma_f32 v[198:199], v[44:45], v[196:197], v[194:195] op_sel_hi:[0,1,1] neg_lo:[0,0,1] neg_hi:[0,0,1]
    v_cvt_pk_bf16_f32 v242, v184, v186
    v_cvt_pk_bf16_f32 v214, v185, v187
    v_cvt_pk_bf16_f32 v243, v188, v190
    v_cvt_pk_bf16_f32 v215, v189, v191
    v_cvt_pk_bf16_f32 v244, v192, v194
    v_cvt_pk_bf16_f32 v216, v193, v195
    v_cvt_pk_bf16_f32 v245, v196, v198
    v_cvt_pk_bf16_f32 v217, v197, v199
    v_fmamk_f32 v48, v42, 0x42000000, v43
    v_cos_f32 v168, v48
    v_sin_f32 v169, v48
    v_fmamk_f32 v48, v42, 0x42040000, v43
    v_cos_f32 v170, v48
    v_sin_f32 v171, v48
    s_nop 0
    v_pk_fma_f32 v[172:173], v[44:45], v[170:171], v[168:169] op_sel_hi:[0,1,1] neg_lo:[0,0,1] neg_hi:[0,0,1]
    v_pk_fma_f32 v[174:175], v[44:45], v[172:173], v[170:171] op_sel_hi:[0,1,1] neg_lo:[0,0,1] neg_hi:[0,0,1]
    v_pk_fma_f32 v[176:177], v[44:45], v[174:175], v[172:173] op_sel_hi:[0,1,1] neg_lo:[0,0,1] neg_hi:[0,0,1]
    v_pk_fma_f32 v[178:179], v[44:45], v[176:177], v[174:175] op_sel_hi:[0,1,1] neg_lo:[0,0,1] neg_hi:[0,0,1]
    v_pk_fma_f32 v[180:181], v[44:45], v[178:179], v[176:177] op_sel_hi:[0,1,1] neg_lo:[0,0,1] neg_hi:[0,0,1]
    v_pk_fma_f32 v[182:183], v[44:45], v[180:181], v[178:179] op_sel_hi:[0,1,1] neg_lo:[0,0,1] neg_hi:[0,0,1]
    v_cvt_pk_bf16_f32 v246, v168, v170
    v_cvt_pk_bf16_f32 v218, v169, v171
    v_cvt_pk_bf16_f32 v247, v172, v174
    v_cvt_pk_bf16_f32 v219, v173, v175
    v_cvt_pk_bf16_f32 v248, v176, v178
    v_cvt_pk_bf16_f32 v220, v177, v179
    v_cvt_pk_bf16_f32 v249, v180, v182
    v_cvt_pk_bf16_f32 v221, v181, v183
    v_pk_fma_f32 v[152:153], v[46:47], v[168:169], v[184:185] op_sel_hi:[0,1,1] neg_lo:[0,0,1] neg_hi:[0,0,1]
    v_pk_fma_f32 v[154:155], v[46:47], v[170:171], v[186:187] op_sel_hi:[0,1,1] neg_lo:[0,0,1] neg_hi:[0,0,1]
    v_pk_fma_f32 v[156:157], v[46:47], v[172:173], v[188:189] op_sel_hi:[0,1,1] neg_lo:[0,0,1] neg_hi:[0,0,1]
    v_pk_fma_f32 v[158:159], v[46:47], v[174:175], v[190:191] op_sel_hi:[0,1,1] neg_lo:[0,0,1] neg_hi:[0,0,1]
    v_pk_fma_f32 v[160:161], v[46:47], v[176:177], v[192:193] op_sel_hi:[0,1,1] neg_lo:[0,0,1] neg_hi:[0,0,1]
    v_pk_fma_f32 v[162:163], v[46:47], v[178:179], v[194:195] op_sel_hi:[0,1,1] neg_lo:[0,0,1] neg_hi:[0,0,1]
    v_pk_fma_f32 v[164:165], v[46:47], v[180:181], v[196:197] op_sel_hi:[0,1,1] neg_lo:[0,0,1] neg_hi:[0,0,1]
    v_pk_fma_f32 v[166:167], v[46:47], v[182:183], v[198:199] op_sel_hi:[0,1,1] neg_lo:[0,0,1] neg_hi:[0,0,1]
    v_cvt_pk_bf16_f32 v250, v152, v154
    v_cvt_pk_bf16_f32 v222, v153, v155
    v_cvt_pk_bf16_f32 v251, v156, v158
    v_cvt_pk_bf16_f32 v223, v157, v159
    v_cvt_pk_bf16_f32 v252, v160, v162
    v_cvt_pk_bf16_f32 v224, v161, v163
    v_cvt_pk_bf16_f32 v253, v164, v166
    v_cvt_pk_bf16_f32 v225, v165, v167
    v_mul_f32 v6, 0x41000000, v9
    v_add_f32 v6, 0x43410000, v6
    v_mul_f32 v43, v33, v6
    v_cos_f32 v44, v42
    s_nop 0
    v_add_f32 v44, v44, v44
    v_cos_f32 v192, v43
    v_sin_f32 v193, v43
    v_fmamk_f32 v48, v42, 0x3f800000, v43
    v_cos_f32 v194, v48
    v_sin_f32 v195, v48
    s_nop 0
    v_pk_fma_f32 v[196:197], v[44:45], v[194:195], v[192:193] op_sel_hi:[0,1,1] neg_lo:[0,0,1] neg_hi:[0,0,1]
    v_pk_fma_f32 v[198:199], v[44:45], v[196:197], v[194:195] op_sel_hi:[0,1,1] neg_lo:[0,0,1] neg_hi:[0,0,1]
    v_cvt_pk_bf16_f32 v254, v192, v194
    v_cvt_pk_bf16_f32 v226, v193, v195
    v_cvt_pk_bf16_f32 v255, v196, v198
    v_cvt_pk_bf16_f32 v227, v197, v199
    v_cmp_eq_f32 vcc, 0, v33
    v_mov_b32 v6, 0x3f80bf80
    s_nop 0
    v_cndmask_b32 v214, v214, v6, vcc
    v_cndmask_b32 v215, v215, v6, vcc
    v_cndmask_b32 v216, v216, v6, vcc
    s_mul_i32 s68, s2, 3600
    buffer_load_ushort v26, v32, s[80:83], s68 offen offset:448
    buffer_load_ushort v27, v32, s[84:87], s68 offen offset:448
    s_cmp_ge_u32 s2, 224
    s_cselect_b32 s82, 0, s82
    s_cselect_b32 s86, 0, s86
    v_cndmask_b32 v217, v217, v6, vcc
    v_cndmask_b32 v218, v218, v6, vcc
    v_cndmask_b32 v219, v219, v6, vcc
    v_cndmask_b32 v220, v220, v6, vcc
    v_cndmask_b32 v221, v221, v6, vcc
    v_cndmask_b32 v222, v222, v6, vcc
    v_cndmask_b32 v223, v223, v6, vcc
    v_cndmask_b32 v224, v224, v6, vcc
    v_cndmask_b32 v225, v225, v6, vcc
    v_cndmask_b32 v226, v226, v6, vcc
    v_cndmask_b32 v227, v227, v6, vcc
    s_waitcnt lgkmcnt(0)
    s_add_u32 s29, s29, 0x9e3779b9
    s_getreg_b32 s25, hwreg(HW_REG_XCC_ID, 0, 4)
    v_mov_b32 v14, s29
    v_mov_b32 v15, s25
    s_cmp_ge_u32 s3, 56
    s_cbranch_scc1 ad_nm3_7
    s_waitcnt vmcnt(10)
    v_lshlrev_b32 v17, 16, v17
    v_mul_f32 v6, 0xbfb8aa3b, v17
    v_exp_f32 v6, v6
    v_lshlrev_b32 v7, 1, v0
    v_add_f32 v6, 1.0, v6
    v_rcp_f32 v6, v6
    v_add_u32 v7, 158208, v7
    v_mul_f32 v17, v17, v6
    v_cvt_pk_bf16_f32 v17, v17, v17
    ds_write_b16 v7, v17
    v_bfe_u32 v6, v0, 2, 2
    v_lshl_add_u32 v7, v3, 3, v6
    v_lshl_add_u32 v6, v3, 2, v6
    v_and_b32 v44, 3, v0
    s_lshl_b32 s25, s22, 5
    s_add_u32 s25, s25, 94208
    v_lshl_add_u32 v44, v44, 3, s25
    v_lshl_add_u32 v7, v7, 7, v44
    v_lshl_add_u32 v6, v6, 7, v44
    v_lshlrev_b32 v45, 4, v3
    v_add_u32 v45, 158208, v45
    v_lshlrev_b32 v46, 3, v3
    v_add_u32 v46, 158400, v46
    s_waitcnt vmcnt(6) lgkmcnt(0)
    s_barrier
    ds_read_b128 v[172:175], v45 offset:0
    ds_read_b64_tr_b16 v[186:187], v7 offset:0
    ds_read_b64_tr_b16 v[188:189], v7 offset:512
    ds_read_b128 v[176:179], v45 offset:64
    ds_read_b64_tr_b16 v[190:191], v7 offset:4096
    ds_read_b64_tr_b16 v[192:193], v7 offset:4608
    ds_read_b128 v[180:183], v45 offset:128
    ds_read_b64_tr_b16 v[194:195], v7 offset:8192
    ds_read_b64_tr_b16 v[196:197], v7 offset:8704
    ds_read_b64 v[184:185], v46
    ds_read_b64_tr_b16 v[198:199], v6 offset:12288
    v_and_b32 v6, 0x33, v1
    v_cmp_eq_u32 vcc, 0, v6
    v_lshlrev_b32 v6, 2, v1
    s_nop 0
    v_cndmask_b32 v6, v8, v6, vcc
    s_mov_b32 s25, 0x07060503
    s_mov_b32 s26, 0x07060502
    s_mov_b32 s27, 0x07060501
    s_waitcnt lgkmcnt(8)
    v_mfma_f32_16x16x32_bf16 v[44:47], v[172:175], v[186:189], 0
    s_waitcnt lgkmcnt(5)
    v_mfma_f32_16x16x32_bf16 v[44:47], v[176:179], v[190:193], v[44:47]
    s_waitcnt lgkmcnt(2)
    v_mfma_f32_16x16x32_bf16 v[44:47], v[180:183], v[194:197], v[44:47]
    s_waitcnt lgkmcnt(0)
    s_nop 4
    v_mfma_f32_16x16x16_bf16 v[44:47], v[184:185], v[198:199], v[44:47]
    s_nop 7
    v_mov_b32_dpp v187, v44 quad_perm:[1,1,1,1] row_mask:0xf bank_mask:0xf
    v_mov_b32_dpp v188, v44 quad_perm:[2,2,2,2] row_mask:0xf bank_mask:0xf
    v_mov_b32_dpp v189, v44 quad_perm:[3,3,3,3] row_mask:0xf bank_mask:0xf
    v_perm_b32 v44, v44, v189, s25
    v_perm_b32 v45, v187, v189, s26
    v_perm_b32 v46, v188, v189, s27
    v_mov_b32 v47, v14
    buffer_store_dwordx4 v[44:47], v6, s[52:55], s33 offen sc1
    buffer_store_dwordx4 v[28:31], v4, s[52:55], s75 offen sc1
    buffer_store_dwordx4 v[28:31], v4, s[52:55], s76 offen sc1
    s_cmp_eq_u32 s88, 0
    s_cselect_b32 s25, s79, 0x40000000
    buffer_store_dwordx4 v[28:31], v25, s[52:55], s25 offen sc1
ad_nm3_7:
    s_lshl_b32 s25, s30, 5
    s_add_u32 s25, s25, s34
    s_add_u32 s25, s25, 96
    v_lshl_add_u32 v6, v2, 1, s25
    s_add_u32 m0, s78, 0
    s_nop 0
    buffer_load_dwordx4 v21, s[80:83], s77 offen nt lds
    v_cvt_f32_u32 v33, v6
    v_mul_f32 v33, 0xba924925, v33
    v_add_f32 v42, v33, v33
    v_mul_f32 v6, 0x41800000, v9
    v_fma_f32 v43, v33, v6, v33
    v_cos_f32 v44, v42
    v_mul_f32 v48, 0x42000000, v42
    v_cos_f32 v46, v48
    v_add_f32 v44, v44, v44
    v_add_f32 v46, v46, v46
    v_cos_f32 v184, v43
    v_sin_f32 v185, v43
    v_fmamk_f32 v48, v42, 0x3f800000, v43
    v_cos_f32 v186, v48
    v_sin_f32 v187, v48
    s_add_u32 m0, s78, 1024
    s_nop 0
    buffer_load_dwordx4 v21, s[84:87], s77 offen nt lds
    s_add_u32 s77, s77, 460800
    v_pk_fma_f32 v[188:189], v[44:45], v[186:187], v[184:185] op_sel_hi:[0,1,1] neg_lo:[0,0,1] neg_hi:[0,0,1]
    v_pk_fma_f32 v[190:191], v[44:45], v[188:189], v[186:187] op_sel_hi:[0,1,1] neg_lo:[0,0,1] neg_hi:[0,0,1]
    v_pk_fma_f32 v[192:193], v[44:45], v[190:191], v[188:189] op_sel_hi:[0,1,1] neg_lo:[0,0,1] neg_hi:[0,0,1]
    v_pk_fma_f32 v[194:195], v[44:45], v[192:193], v[190:191] op_sel_hi:[0,1,1] neg_lo:[0,0,1] neg_hi:[0,0,1]
    v_pk_fma_f32 v[196:197], v[44:45], v[194:195], v[192:193] op_sel_hi:[0,1,1] neg_lo:[0,0,1] neg_hi:[0,0,1]
    v_pk_fma_f32 v[198:199], v[44:45], v[196:197], v[194:195] op_sel_hi:[0,1,1] neg_lo:[0,0,1] neg_hi:[0,0,1]
    v_cvt_pk_bf16_f32 v228, v184, v186
    v_cvt_pk_bf16_f32 v200, v185, v187
    v_cvt_pk_bf16_f32 v229, v188, v190
    v_cvt_pk_bf16_f32 v201, v189, v191
    v_cvt_pk_bf16_f32 v230, v192, v194
    v_cvt_pk_bf16_f32 v202, v193, v195
    v_cvt_pk_bf16_f32 v231, v196, v198
    v_cvt_pk_bf16_f32 v203, v197, v199
    v_fmamk_f32 v48, v42, 0x42000000, v43
    v_cos_f32 v168, v48
    v_sin_f32 v169, v48
    v_fmamk_f32 v48, v42, 0x42040000, v43
    s_add_u32 m0, s78, 2048
    s_nop 0
    buffer_load_dwordx4 v21, s[80:83], s77 offen nt lds
    v_cos_f32 v170, v48
    v_sin_f32 v171, v48
    s_nop 0
    v_pk_fma_f32 v[172:173], v[44:45], v[170:171], v[168:169] op_sel_hi:[0,1,1] neg_lo:[0,0,1] neg_hi:[0,0,1]
    v_pk_fma_f32 v[174:175], v[44:45], v[172:173], v[170:171] op_sel_hi:[0,1,1] neg_lo:[0,0,1] neg_hi:[0,0,1]
    v_pk_fma_f32 v[176:177], v[44:45], v[174:175], v[172:173] op_sel_hi:[0,1,1] neg_lo:[0,0,1] neg_hi:[0,0,1]
    v_pk_fma_f32 v[178:179], v[44:45], v[176:177], v[174:175] op_sel_hi:[0,1,1] neg_lo:[0,0,1] neg_hi:[0,0,1]
    v_pk_fma_f32 v[180:181], v[44:45], v[178:179], v[176:177] op_sel_hi:[0,1,1] neg_lo:[0,0,1] neg_hi:[0,0,1]
    v_pk_fma_f32 v[182:183], v[44:45], v[180:181], v[178:179] op_sel_hi:[0,1,1] neg_lo:[0,0,1] neg_hi:[0,0,1]
    v_cvt_pk_bf16_f32 v232, v168, v170
    v_cvt_pk_bf16_f32 v204, v169, v171
    v_cvt_pk_bf16_f32 v233, v172, v174
    v_cvt_pk_bf16_f32 v205, v173, v175
    v_cvt_pk_bf16_f32 v234, v176, v178
    v_cvt_pk_bf16_f32 v206, v177, v179
    v_cvt_pk_bf16_f32 v235, v180, v182
    v_cvt_pk_bf16_f32 v207, v181, v183
    v_pk_fma_f32 v[152:153], v[46:47], v[168:169], v[184:185] op_sel_hi:[0,1,1] neg_lo:[0,0,1] neg_hi:[0,0,1]
    v_pk_fma_f32 v[154:155], v[46:47], v[170:171], v[186:187] op_sel_hi:[0,1,1] neg_lo:[0,0,1] neg_hi:[0,0,1]
    s_add_u32 m0, s78, 3072
    s_nop 0
    buffer_load_dwordx4 v21, s[84:87], s77 offen nt lds
    s_add_u32 s77, s77, 460800
    v_pk_fma_f32 v[156:157], v[46:47], v[172:173], v[188:189] op_sel_hi:[0,1,1] neg_lo:[0,0,1] neg_hi:[0,0,1]
    v_pk_fma_f32 v[158:159], v[46:47], v[174:175], v[190:191] op_sel_hi:[0,1,1] neg_lo:[0,0,1] neg_hi:[0,0,1]
    v_pk_fma_f32 v[160:161], v[46:47], v[176:177], v[192:193] op_sel_hi:[0,1,1] neg_lo:[0,0,1] neg_hi:[0,0,1]
    v_pk_fma_f32 v[162:163], v[46:47], v[178:179], v[194:195] op_sel_hi:[0,1,1] neg_lo:[0,0,1] neg_hi:[0,0,1]
    v_pk_fma_f32 v[164:165], v[46:47], v[180:181], v[196:197] op_sel_hi:[0,1,1] neg_lo:[0,0,1] neg_hi:[0,0,1]
    v_pk_fma_f32 v[166:167], v[46:47], v[182:183], v[198:199] op_sel_hi:[0,1,1] neg_lo:[0,0,1] neg_hi:[0,0,1]
    v_cvt_pk_bf16_f32 v236, v152, v154
    v_cvt_pk_bf16_f32 v208, v153, v155
    v_cvt_pk_bf16_f32 v237, v156, v158
    v_cvt_pk_bf16_f32 v209, v157, v159
    v_cvt_pk_bf16_f32 v238, v160, v162
    v_cvt_pk_bf16_f32 v210, v161, v163
    v_cvt_pk_bf16_f32 v239, v164, v166
    v_cvt_pk_bf16_f32 v211, v165, v167
    v_mul_f32 v6, 0x41000000, v9
    v_add_f32 v6, 0x43410000, v6
    v_mul_f32 v43, v33, v6
    v_cos_f32 v44, v42
    s_nop 0
    v_add_f32 v44, v44, v44
    v_cos_f32 v192, v43
    v_sin_f32 v193, v43
    v_fmamk_f32 v48, v42, 0x3f800000, v43
    v_cos_f32 v194, v48
    v_sin_f32 v195, v48
    s_nop 0
    v_pk_fma_f32 v[196:197], v[44:45], v[194:195], v[192:193] op_sel_hi:[0,1,1] neg_lo:[0,0,1] neg_hi:[0,0,1]
    v_pk_fma_f32 v[198:199], v[44:45], v[196:197], v[194:195] op_sel_hi:[0,1,1] neg_lo:[0,0,1] neg_hi:[0,0,1]
    v_cvt_pk_bf16_f32 v240, v192, v194
    v_cvt_pk_bf16_f32 v212, v193, v195
    v_cvt_pk_bf16_f32 v241, v196, v198
    v_cvt_pk_bf16_f32 v213, v197, v199
    v_lshrrev_b32 v6, 1, v2
    v_and_b32 v33, 1, v2
    v_lshl_add_u32 v6, v33, 3, v6
    v_cvt_f32_u32 v33, v6
    v_mul_f32 v33, 0x3a000000, v33
    v_lshl_add_u32 v6, v3, 9, s23
    v_cvt_f32_u32 v6, v6
    v_mul_f32 v42, v33, v6
    v_cos_f32 v192, v42
    v_sin_f32 v196, v42
    v_fmamk_f32 v6, v33, 0x43000000, v42
    v_cos_f32 v193, v6
    v_sin_f32 v197, v6
    v_fmamk_f32 v6, v33, 0x43800000, v42
    v_cos_f32 v194, v6
    v_sin_f32 v198, v6
    v_fmamk_f32 v6, v33, 0x43c00000, v42
    v_cos_f32 v195, v6
    v_sin_f32 v199, v6
    v_cvt_pk_bf16_f32 v46, v192, v193
    v_cvt_pk_bf16_f32 v47, v194, v195
    v_cvt_pk_bf16_f32 v48, v196, v197
    v_cvt_pk_bf16_f32 v49, v198, v199
    v_cvt_pk_bf16_f32 v44, -v196, -v197
    v_cvt_pk_bf16_f32 v45, -v198, -v199
    s_bitcmp1_b32 s23, 2
    s_cselect_b64 vcc, -1, 0
    v_cndmask_b32 v34, v46, v44, vcc
    v_cndmask_b32 v38, v44, v46, vcc
    v_cndmask_b32 v35, v47, v45, vcc
    v_cndmask_b32 v39, v45, v47, vcc
    v_cndmask_b32 v36, v48, v46, vcc
    v_cndmask_b32 v40, v46, v48, vcc
    v_cndmask_b32 v37, v49, v47, vcc
    v_cndmask_b32 v41, v47, v49, vcc
    v_cmp_eq_u32 vcc, 0, v0
    s_nop 1
    v_cndmask_b32 v10, v8, v0, vcc
    s_lshl_b32 s38, s2, 5
    s_add_u32 s38, s38, 0x18000
    s_mul_i32 s25, s22, 3648
    s_add_u32 s25, s25, 131072
    v_mul_u32_u24 v6, 912, v3
    v_add_u32 v6, s25, v6
    v_lshlrev_b32 v7, 4, v2
    v_add_u32 v28, v6, v7
    v_sub_u32 v29, v6, v7
    s_lshl_b32 s25, s22, 5
    v_lshl_add_u32 v12, v3, 3, s25
    v_mul_u32_u24 v6, 912, v2
    v_add_u32 v6, 131072, v6
    v_sub_u32 v7, v6, v12
    v_add_u32 v6, v6, v12
    s_waitcnt vmcnt(6)
    s_barrier
    ds_read_b128 v[184:187], v28 offset:0
    ds_read_b128 v[188:191], v28 offset:448
    ds_read_b128 v[192:195], v29 offset:432
    ds_read_b128 v[196:199], v29 offset:880
    ds_read_b64 v[168:169], v6 offset:0
    ds_read_b64 v[170:171], v6 offset:448
    ds_read_b64 v[172:173], v7 offset:440
    ds_read_b64 v[174:175], v7 offset:888
    ds_read_b64 v[176:177], v6 offset:128
    ds_read_b64 v[178:179], v6 offset:576
    ds_read_b64 v[180:181], v7 offset:312
    ds_read_b64 v[182:183], v7 offset:760
    v_bfe_u32 v6, v0, 5, 1
    v_lshlrev_b32 v11, 10, v6
    v_bfe_u32 v6, v0, 2, 2
    v_lshl_add_u32 v11, v6, 7, v11
    v_bfe_u32 v6, v0, 4, 1
    v_lshl_add_u32 v11, v6, 5, v11
    v_and_b32 v6, 3, v0
    v_lshl_add_u32 v11, v6, 3, v11
    v_add_u32 v28, s73, v11
    s_mov_b32 s26, 0x3f803f80
    s_waitcnt lgkmcnt(11)
    v_dot2_f32_bf16 v30, v184, s26, 0
    v_dot2_f32_bf16 v31, v184, v184, 0
    v_dot2_f32_bf16 v30, v185, s26, v30
    v_dot2_f32_bf16 v31, v185, v185, v31
    v_dot2_f32_bf16 v30, v186, s26, v30
    v_dot2_f32_bf16 v31, v186, v186, v31
    v_dot2_f32_bf16 v30, v187, s26, v30
    v_dot2_f32_bf16 v31, v187, v187, v31
    s_waitcnt lgkmcnt(10)
    v_dot2_f32_bf16 v30, v188, s26, v30
    v_dot2_f32_bf16 v31, v188, v188, v31
    v_dot2_f32_bf16 v30, v189, s26, v30
    v_dot2_f32_bf16 v31, v189, v189, v31
    v_dot2_f32_bf16 v30, v190, s26, v30
    v_dot2_f32_bf16 v31, v190, v190, v31
    v_dot2_f32_bf16 v30, v191, s26, v30
    v_dot2_f32_bf16 v31, v191, v191, v31
    s_waitcnt lgkmcnt(9)
    v_dot2_f32_bf16 v30, v192, s26, v30
    v_dot2_f32_bf16 v31, v192, v192, v31
    v_dot2_f32_bf16 v30, v193, s26, v30
    v_dot2_f32_bf16 v31, v193, v193, v31
    v_dot2_f32_bf16 v30, v194, s26, v30
    v_dot2_f32_bf16 v31, v194, v194, v31
    v_dot2_f32_bf16 v30, v195, s26, v30
    v_dot2_f32_bf16 v31, v195, v195, v31
    s_waitcnt lgkmcnt(8)
    v_dot2_f32_bf16 v30, v196, s26, v30
    v_dot2_f32_bf16 v31, v196, v196, v31
    v_dot2_f32_bf16 v30, v197, s26, v30
    v_dot2_f32_bf16 v31, v197, v197, v31
    v_dot2_f32_bf16 v30, v198, s26, v30
    v_dot2_f32_bf16 v31, v198, v198, v31
    v_dot2_f32_bf16 v30, v199, s26, v30
    v_dot2_f32_bf16 v31, v199, v199, v31
    v_cmp_gt_u32 vcc, 14, v2
    s_nop 1
    v_cndmask_b32 v30, 0, v30, vcc
    v_cndmask_b32 v31, 0, v31, vcc
    s_nop 0
    v_add_f32_dpp v30, v30, v30 row_ror:8 row_mask:0xf bank_mask:0xf
    v_add_f32_dpp v31, v31, v31 row_ror:8 row_mask:0xf bank_mask:0xf
    v_lshlrev_b32 v136, 16, v184
    v_and_b32 v137, 0xffff0000, v184
    v_lshlrev_b32 v138, 16, v185
    v_and_b32 v139, 0xffff0000, v185
    v_lshlrev_b32 v140, 16, v186
    v_and_b32 v141, 0xffff0000, v186
    v_lshlrev_b32 v142, 16, v187
    v_and_b32 v143, 0xffff0000, v187
    v_add_f32_dpp v30, v30, v30 row_ror:4 row_mask:0xf bank_mask:0xf
    v_add_f32_dpp v31, v31, v31 row_ror:4 row_mask:0xf bank_mask:0xf
    v_lshlrev_b32 v144, 16, v188
    v_and_b32 v145, 0xffff0000, v188
    v_lshlrev_b32 v146, 16, v189
    v_and_b32 v147, 0xffff0000, v189
    v_lshlrev_b32 v148, 16, v190
    v_and_b32 v149, 0xffff0000, v190
    v_lshlrev_b32 v150, 16, v191
    v_and_b32 v151, 0xffff0000, v191
    v_add_f32_dpp v30, v30, v30 row_ror:2 row_mask:0xf bank_mask:0xf
    v_add_f32_dpp v31, v31, v31 row_ror:2 row_mask:0xf bank_mask:0xf
    v_and_b32 v152, 0xffff0000, v195
    v_lshlrev_b32 v153, 16, v195
    v_and_b32 v154, 0xffff0000, v194
    v_lshlrev_b32 v155, 16, v194
    v_and_b32 v156, 0xffff0000, v193
    v_lshlrev_b32 v157, 16, v193
    v_and_b32 v158, 0xffff0000, v192
    v_lshlrev_b32 v159, 16, v192
    v_add_f32_dpp v30, v30, v30 row_ror:1 row_mask:0xf bank_mask:0xf
    v_add_f32_dpp v31, v31, v31 row_ror:1 row_mask:0xf bank_mask:0xf
    v_and_b32 v160, 0xffff0000, v199
    v_lshlrev_b32 v161, 16, v199
    v_and_b32 v162, 0xffff0000, v198
    v_lshlrev_b32 v163, 16, v198
    v_and_b32 v164, 0xffff0000, v197
    v_lshlrev_b32 v165, 16, v197
    v_and_b32 v166, 0xffff0000, v196
    v_lshlrev_b32 v167, 16, v196
    s_mov_b32 s26, 0x3b124925
    v_mul_f32 v30, s26, v30
    v_mul_f32 v6, v30, v30
    v_fma_f32 v31, v31, s26, -v6
    v_max_f32 v31, 0, v31
    v_add_f32 v31, 0x3727c5ac, v31
    v_rsq_f32 v31, v31
    s_nop 0
    v_mul_f32 v30, -v30, v31
    v_pk_fma_f32 v[136:137], v[136:137], v[30:31], v[30:31] op_sel:[0,1,0] op_sel_hi:[1,1,0]
    v_pk_fma_f32 v[138:139], v[138:139], v[30:31], v[30:31] op_sel:[0,1,0] op_sel_hi:[1,1,0]
    v_pk_fma_f32 v[140:141], v[140:141], v[30:31], v[30:31] op_sel:[0,1,0] op_sel_hi:[1,1,0]
    v_pk_fma_f32 v[142:143], v[142:143], v[30:31], v[30:31] op_sel:[0,1,0] op_sel_hi:[1,1,0]
    v_pk_fma_f32 v[144:145], v[144:145], v[30:31], v[30:31] op_sel:[0,1,0] op_sel_hi:[1,1,0]
    v_pk_fma_f32 v[146:147], v[146:147], v[30:31], v[30:31] op_sel:[0,1,0] op_sel_hi:[1,1,0]
    v_pk_fma_f32 v[148:149], v[148:149], v[30:31], v[30:31] op_sel:[0,1,0] op_sel_hi:[1,1,0]
    v_pk_fma_f32 v[150:151], v[150:151], v[30:31], v[30:31] op_sel:[0,1,0] op_sel_hi:[1,1,0]
    v_pk_fma_f32 v[152:153], v[152:153], v[30:31], v[30:31] op_sel:[0,1,0] op_sel_hi:[1,1,0]
    v_pk_fma_f32 v[154:155], v[154:155], v[30:31], v[30:31] op_sel:[0,1,0] op_sel_hi:[1,1,0]
    v_pk_fma_f32 v[156:157], v[156:157], v[30:31], v[30:31] op_sel:[0,1,0] op_sel_hi:[1,1,0]
    v_pk_fma_f32 v[158:159], v[158:159], v[30:31], v[30:31] op_sel:[0,1,0] op_sel_hi:[1,1,0]
    v_pk_fma_f32 v[160:161], v[160:161], v[30:31], v[30:31] op_sel:[0,1,0] op_sel_hi:[1,1,0]
    v_pk_fma_f32 v[162:163], v[162:163], v[30:31], v[30:31] op_sel:[0,1,0] op_sel_hi:[1,1,0]
    v_pk_fma_f32 v[164:165], v[164:165], v[30:31], v[30:31] op_sel:[0,1,0] op_sel_hi:[1,1,0]
    v_pk_fma_f32 v[166:167], v[166:167], v[30:31], v[30:31] op_sel:[0,1,0] op_sel_hi:[1,1,0]
    v_cmp_gt_u32 vcc, 224, v0
    s_nop 1
    v_cndmask_b32 v31, v8, v5, vcc
    v_cndmask_b32 v30, 0, v14, vcc
    s_mov_b64 s[8:9], vcc
    s_and_b32 s25, s2, 7
    s_lshl_b32 s25, s25, 5
    v_lshl_add_u32 v42, v1, 8, s25
    v_lshlrev_b32 v33, 5, v0
    v_cmp_gt_u32 vcc, 32, v1
    s_nop 1
    v_cndmask_b32 v42, v8, v42, vcc
    v_cndmask_b32 v43, 0, v14, vcc
    s_mov_b32 s3, 0x18000
    s_waitcnt vmcnt(4)
    s_barrier
    buffer_store_dwordx2 v[14:15], v10, s[52:55], s38 offen sc1
    s_add_u32 s38, s38, 0x2000
    v_add_u32 v29, 146432, v5
    v_mov_b32 v7, 0
    v_cmp_gt_u32 vcc, 112, v0
    s_nop 1
    v_cndmask_b32 v44, 1.0, v7, vcc
    s_lshl_b32 s25, s22, 2
    v_add_u32 v6, s25, v3
    v_and_b32 v7, 7, v2
    v_xor_b32 v6, v6, v7
    v_lshlrev_b32 v6, 4, v6
    v_lshl_add_u32 v45, v2, 8, v6
    v_add_u32 v45, 131072, v45
    v_xor_b32 v6, v2, v3
    v_lshlrev_b32 v6, 4, v6
    v_lshl_add_u32 v46, v3, 8, v6
    v_add_u32 v46, 131072, v46
    v_xor_b32 v47, 64, v46
    v_lshrrev_b32 v6, 1, v3
    v_or_b32 v7, 4, v6
    v_xor_b32 v7, v7, v2
    v_lshlrev_b32 v7, 4, v7
    v_lshl_add_u32 v48, v6, 8, v7
    v_and_b32 v6, 1, v3
    v_lshl_add_u32 v48, v6, 3, v48
    v_add_u32 v48, 134144, v48
    v_lshlrev_b32 v6, 5, v2
    v_add_u32 v49, 146432, v6
    v_sub_u32 v50, 147296, v6
    s_cmp_eq_u32 s34, 0
    s_cselect_b32 s10, 1.0, -1.0
    s_mov_b32 s11, s10
    s_lshl_b32 s25, s22, 4
    v_add_u32 v6, s25, v2
    v_cvt_f32_u32 v51, v6
    v_mul_f32 v51, 0x3c000000, v51
    v_mul_f32 v6, 4.0, v9
    v_mul_f32 v52, v51, v6
    v_cos_f32 v58, v51
    v_mul_f32 v53, 0x41800000, v51
    v_cos_f32 v60, v53
    v_add_f32 v58, v58, v58
    v_add_f32 v60, v60, v60
    v_cos_f32 v128, v52
    v_sin_f32 v129, v52
    v_fmamk_f32 v53, v51, 0x3f800000, v52
    v_cos_f32 v130, v53
    v_sin_f32 v131, v53
    s_nop 0
    v_pk_fma_f32 v[132:133], v[58:59], v[130:131], v[128:129] op_sel_hi:[0,1,1] neg_lo:[0,0,1] neg_hi:[0,0,1]
    v_pk_fma_f32 v[134:135], v[58:59], v[132:133], v[130:131] op_sel_hi:[0,1,1] neg_lo:[0,0,1] neg_hi:[0,0,1]
    v_cvt_pk_bf16_f32 v54, v128, v132
    v_cvt_pk_bf16_f32 v56, v129, v133
    v_cvt_pk_bf16_f32 v55, v130, v134
    v_cvt_pk_bf16_f32 v57, v131, v135
    v_accvgpr_write_b32 a32, v54
    v_accvgpr_write_b32 a48, v56
    v_accvgpr_write_b32 a40, v55
    v_accvgpr_write_b32 a56, v57
    v_fmamk_f32 v53, v51, 0x41800000, v52
    v_cos_f32 v120, v53
    v_sin_f32 v121, v53
    v_fmamk_f32 v53, v51, 0x41880000, v52
    v_cos_f32 v122, v53
    v_sin_f32 v123, v53
    s_nop 0
    v_pk_fma_f32 v[124:125], v[58:59], v[122:123], v[120:121] op_sel_hi:[0,1,1] neg_lo:[0,0,1] neg_hi:[0,0,1]
    v_pk_fma_f32 v[126:127], v[58:59], v[124:125], v[122:123] op_sel_hi:[0,1,1] neg_lo:[0,0,1] neg_hi:[0,0,1]
    v_cvt_pk_bf16_f32 v54, v120, v124
    s_mov_b32 s68, 0xa000
    buffer_load_dwordx4 v[184:187], v31, s[52:55], s68 offen sc1
    s_mov_b32 s68, 0xae00
    buffer_load_dwordx4 v[188:191], v31, s[52:55], s68 offen sc1
    s_mov_b32 s68, 0xbc00
    buffer_load_dwordx4 v[192:195], v31, s[52:55], s68 offen sc1
    s_mov_b32 s68, 0xca00
    buffer_load_dwordx4 v[196:199], v31, s[52:55], s68 offen sc1
    s_add_u32 m0, s73, 0
    s_add_u32 s68, s72, 0
    buffer_load_dwordx4 v18, s[64:67], s68 offen nt lds
    s_add_u32 m0, s73, 1024
    s_add_u32 s68, s72, 3584
    buffer_load_dwordx4 v18, s[64:67], s68 offen nt lds
    s_cmp_ge_u32 s24, 56
    s_cbranch_scc1 ad_late_8
    buffer_load_ushort v17, v16, s[40:43], s32 offen
    s_add_u32 m0, s37, 94208
    s_nop 0
    buffer_load_dwordx4 v13, s[44:47], s31 offen nt lds
    s_add_u32 s31, s31, 43008
    s_add_u32 m0, s37, 95232
    s_nop 0
    buffer_load_dwordx4 v13, s[44:47], s31 offen nt lds
    s_add_u32 s31, s31, 43008
    s_add_u32 m0, s37, 96256
    s_nop 0
    buffer_load_dwordx4 v13, s[44:47], s31 offen nt lds
    s_add_u32 s31, s31, 43008
    s_add_u32 m0, s37, 97280
    s_nop 0
    buffer_load_dwordx4 v13, s[44:47], s31 offen nt lds
    s_add_u32 s31, s31, 43008
ad_late_8:
    s_add_u32 m0, s90, 0
    s_add_u32 s68, s89, 0
    buffer_load_dwordx4 v19, s[60:63], s68 offen lds
    s_add_u32 m0, s90, 2048
    s_add_u32 s68, s89, 28672
    buffer_load_dwordx4 v19, s[60:63], s68 offen lds
    s_add_u32 m0, s90, 4096
    s_add_u32 s68, s89, 372736
    buffer_load_dwordx4 v20, s[60:63], s68 offen lds
    v_cvt_pk_bf16_f32 v56, v121, v125
    v_cvt_pk_bf16_f32 v55, v122, v126
    v_cvt_pk_bf16_f32 v57, v123, v127
    v_accvgpr_write_b32 a34, v54
    v_accvgpr_write_b32 a50, v56
    v_accvgpr_write_b32 a42, v55
    v_accvgpr_write_b32 a58, v57
    v_pk_fma_f32 v[112:113], v[60:61], v[120:121], v[128:129] op_sel_hi:[0,1,1] neg_lo:[0,0,1] neg_hi:[0,0,1]
    v_pk_fma_f32 v[114:115], v[60:61], v[122:123], v[130:131] op_sel_hi:[0,1,1] neg_lo:[0,0,1] neg_hi:[0,0,1]
    v_pk_fma_f32 v[116:117], v[60:61], v[124:125], v[132:133] op_sel_hi:[0,1,1] neg_lo:[0,0,1] neg_hi:[0,0,1]
    v_pk_fma_f32 v[118:119], v[60:61], v[126:127], v[134:135] op_sel_hi:[0,1,1] neg_lo:[0,0,1] neg_hi:[0,0,1]
    v_cvt_pk_bf16_f32 v54, v112, v116
    v_cvt_pk_bf16_f32 v56, v113, v117
    v_cvt_pk_bf16_f32 v55, v114, v118
    v_cvt_pk_bf16_f32 v57, v115, v119
    v_accvgpr_write_b32 a36, v54
    v_accvgpr_write_b32 a52, v56
    v_accvgpr_write_b32 a44, v55
    v_accvgpr_write_b32 a60, v57
    v_pk_fma_f32 v[128:129], v[60:61], v[112:113], v[120:121] op_sel_hi:[0,1,1] neg_lo:[0,0,1] neg_hi:[0,0,1]
    v_pk_fma_f32 v[130:131], v[60:61], v[114:115], v[122:123] op_sel_hi:[0,1,1] neg_lo:[0,0,1] neg_hi:[0,0,1]
    v_pk_fma_f32 v[132:133], v[60:61], v[116:117], v[124:125] op_sel_hi:[0,1,1] neg_lo:[0,0,1] neg_hi:[0,0,1]
    v_pk_fma_f32 v[134:135], v[60:61], v[118:119], v[126:127] op_sel_hi:[0,1,1] neg_lo:[0,0,1] neg_hi:[0,0,1]
    v_cvt_pk_bf16_f32 v54, v128, v132
    v_cvt_pk_bf16_f32 v56, v129, v133
    v_cvt_pk_bf16_f32 v55, v130, v134
    v_cvt_pk_bf16_f32 v57, v131, v135
    v_accvgpr_write_b32 a38, v54
    v_accvgpr_write_b32 a54, v56
    v_accvgpr_write_b32 a46, v55
    v_accvgpr_write_b32 a62, v57
    v_pk_fma_f32 v[120:121], v[60:61], v[128:129], v[112:113] op_sel_hi:[0,1,1] neg_lo:[0,0,1] neg_hi:[0,0,1]
    v_pk_fma_f32 v[122:123], v[60:61], v[130:131], v[114:115] op_sel_hi:[0,1,1] neg_lo:[0,0,1] neg_hi:[0,0,1]
    v_pk_fma_f32 v[124:125], v[60:61], v[132:133], v[116:117] op_sel_hi:[0,1,1] neg_lo:[0,0,1] neg_hi:[0,0,1]
    v_pk_fma_f32 v[126:127], v[60:61], v[134:135], v[118:119] op_sel_hi:[0,1,1] neg_lo:[0,0,1] neg_hi:[0,0,1]
    v_cvt_pk_bf16_f32 v54, v120, v124
    v_cvt_pk_bf16_f32 v56, v121, v125
    v_cvt_pk_bf16_f32 v55, v122, v126
    v_cvt_pk_bf16_f32 v57, v123, v127
    v_accvgpr_write_b32 a33, v54
    v_accvgpr_write_b32 a49, v56
    v_accvgpr_write_b32 a41, v55
    v_accvgpr_write_b32 a57, v57
    v_pk_fma_f32 v[112:113], v[60:61], v[120:121], v[128:129] op_sel_hi:[0,1,1] neg_lo:[0,0,1] neg_hi:[0,0,1]
    v_pk_fma_f32 v[114:115], v[60:61], v[122:123], v[130:131] op_sel_hi:[0,1,1] neg_lo:[0,0,1] neg_hi:[0,0,1]
    v_pk_fma_f32 v[116:117], v[60:61], v[124:125], v[132:133] op_sel_hi:[0,1,1] neg_lo:[0,0,1] neg_hi:[0,0,1]
    v_pk_fma_f32 v[118:119], v[60:61], v[126:127], v[134:135] op_sel_hi:[0,1,1] neg_lo:[0,0,1] neg_hi:[0,0,1]
    v_cvt_pk_bf16_f32 v54, v112, v116
    v_cvt_pk_bf16_f32 v56, v113, v117
    v_cvt_pk_bf16_f32 v55, v114, v118
    v_cvt_pk_bf16_f32 v57, v115, v119
    v_accvgpr_write_b32 a35, v54
    v_accvgpr_write_b32 a51, v56
    v_accvgpr_write_b32 a43, v55
    v_accvgpr_write_b32 a59, v57
    v_pk_fma_f32 v[128:129], v[60:61], v[112:113], v[120:121] op_sel_hi:[0,1,1] neg_lo:[0,0,1] neg_hi:[0,0,1]
    v_pk_fma_f32 v[130:131], v[60:61], v[114:115], v[122:123] op_sel_hi:[0,1,1] neg_lo:[0,0,1] neg_hi:[0,0,1]
    v_pk_fma_f32 v[132:133], v[60:61], v[116:117], v[124:125] op_sel_hi:[0,1,1] neg_lo:[0,0,1] neg_hi:[0,0,1]
    v_pk_fma_f32 v[134:135], v[60:61], v[118:119], v[126:127] op_sel_hi:[0,1,1] neg_lo:[0,0,1] neg_hi:[0,0,1]
    v_cvt_pk_bf16_f32 v54, v128, v132
    v_cvt_pk_bf16_f32 v56, v129, v133
    v_cvt_pk_bf16_f32 v55, v130, v134
    v_cvt_pk_bf16_f32 v57, v131, v135
    v_accvgpr_write_b32 a37, v54
    v_accvgpr_write_b32 a53, v56
    v_accvgpr_write_b32 a45, v55
    v_accvgpr_write_b32 a61, v57
    v_pk_fma_f32 v[120:121], v[60:61], v[128:129], v[112:113] op_sel_hi:[0,1,1] neg_lo:[0,0,1] neg_hi:[0,0,1]
    v_pk_fma_f32 v[122:123], v[60:61], v[130:131], v[114:115] op_sel_hi:[0,1,1] neg_lo:[0,0,1] neg_hi:[0,0,1]
    v_pk_fma_f32 v[124:125], v[60:61], v[132:133], v[116:117] op_sel_hi:[0,1,1] neg_lo:[0,0,1] neg_hi:[0,0,1]
    v_pk_fma_f32 v[126:127], v[60:61], v[134:135], v[118:119] op_sel_hi:[0,1,1] neg_lo:[0,0,1] neg_hi:[0,0,1]
    v_cvt_pk_bf16_f32 v54, v120, v124
    v_cvt_pk_bf16_f32 v56, v121, v125
    v_cvt_pk_bf16_f32 v55, v122, v126
    v_cvt_pk_bf16_f32 v57, v123, v127
    v_accvgpr_write_b32 a39, v54
    v_accvgpr_write_b32 a55, v56
    v_accvgpr_write_b32 a47, v55
    v_accvgpr_write_b32 a63, v57
    s_mov_b32 s28, 100001
    s_waitcnt vmcnt(8)
    v_xor_b32 v187, v187, v30
    s_waitcnt vmcnt(7)
    v_xor_b32 v191, v191, v30
    v_or3_b32 v6, v187, v191, 0
    s_waitcnt vmcnt(6)
    v_xor_b32 v195, v195, v30
    s_waitcnt vmcnt(5)
    v_xor_b32 v199, v199, v30
    v_or3_b32 v6, v195, v199, v6
    v_cmp_ne_u32 vcc, 0, v6
    s_nop 4
    s_cbranch_vccz ad_ok_9
    s_mov_b32 s28, 100000
ad_poll_10:
    s_mov_b32 s68, 0xa000
    buffer_load_dwordx4 v[184:187], v31, s[52:55], s68 offen sc1
    s_mov_b32 s68, 0xae00
    buffer_load_dwordx4 v[188:191], v31, s[52:55], s68 offen sc1
    s_mov_b32 s68, 0xbc00
    buffer_load_dwordx4 v[192:195], v31, s[52:55], s68 offen sc1
    s_mov_b32 s68, 0xca00
    buffer_load_dwordx4 v[196:199], v31, s[52:55], s68 offen sc1
    s_waitcnt vmcnt(3)
    v_xor_b32 v187, v187, v30
    s_waitcnt vmcnt(2)
    v_xor_b32 v191, v191, v30
    v_or3_b32 v6, v187, v191, 0
    s_waitcnt vmcnt(1)
    v_xor_b32 v195, v195, v30
    s_waitcnt vmcnt(0)
    v_xor_b32 v199, v199, v30
    v_or3_b32 v6, v195, v199, v6
    v_cmp_ne_u32 vcc, 0, v6
    s_nop 4
    s_cbranch_vccz ad_ok_11
    s_sleep 6
    s_sub_u32 s28, s28, 1
    s_cmp_lg_u32 s28, 0
    s_cbranch_scc1 ad_poll_10
ad_ok_11:
ad_ok_9:
    s_mov_b32 s25, 0x04000c0c
    s_mov_b32 s26, 0x0706000c
    v_perm_b32 v187, v184, v185, s25
    v_perm_b32 v191, v188, v189, s25
    v_perm_b32 v195, v192, v193, s25
    v_perm_b32 v199, v196, v197, s25
    v_perm_b32 v187, v187, v186, s26
    v_perm_b32 v191, v191, v190, s26
    v_perm_b32 v195, v195, v194, s26
    v_perm_b32 v199, v199, v198, s26
    v_pk_add_f32 v[184:185], v[184:185], v[188:189]
    v_pk_add_f32 v[186:187], v[186:187], v[190:191]
    v_pk_add_f32 v[192:193], v[192:193], v[196:197]
    v_pk_add_f32 v[194:195], v[194:195], v[198:199]
    v_pk_add_f32 v[184:185], v[184:185], v[192:193]
    v_pk_add_f32 v[186:187], v[186:187], v[194:195]
    v_cvt_pk_bf16_f32 v188, v184, v185
    v_cvt_pk_bf16_f32 v189, v186, v187
    v_lshlrev_b32 v184, 16, v188
    v_and_b32 v185, 0xffff0000, v188
    v_lshlrev_b32 v186, 16, v189
    v_and_b32 v187, 0xffff0000, v189
    v_add_f32 v184, v184, v44
    v_add_f32 v185, v185, v44
    v_add_f32 v186, v186, v44
    v_add_f32 v187, v187, v44
    v_cvt_pk_bf16_f32 v188, v184, v185
    v_cvt_pk_bf16_f32 v189, v186, v187
    v_lshlrev_b32 v184, 16, v188
    v_and_b32 v185, 0xffff0000, v188
    v_lshlrev_b32 v186, 16, v189
    v_and_b32 v187, 0xffff0000, v189
    s_mov_b64 exec, s[8:9]
    ds_write_b128 v29, v[184:187] offset:0
    s_mov_b64 exec, -1
    s_waitcnt lgkmcnt(0)
    s_barrier
    ds_read_b128 v[104:107], v49 offset:0
    ds_read_b128 v[108:111], v49 offset:16
    ds_read_b128 v[184:187], v49 offset:1792
    ds_read_b128 v[188:191], v49 offset:1808
    ds_read_b128 v[112:115], v49 offset:896
    ds_read_b128 v[116:119], v49 offset:912
    ds_read_b128 v[192:195], v49 offset:2688
    ds_read_b128 v[196:199], v49 offset:2704
    ds_read_b128 v[120:123], v50 offset:0
    ds_read_b128 v[124:127], v50 offset:16
    ds_read_b128 v[88:91], v50 offset:1792
    ds_read_b128 v[92:95], v50 offset:1808
    ds_read_b128 v[128:131], v50 offset:896
    ds_read_b128 v[132:135], v50 offset:912
    ds_read_b128 v[96:99], v50 offset:2688
    ds_read_b128 v[100:103], v50 offset:2704
    s_waitcnt lgkmcnt(13)
    v_pk_fma_f32 v[136:137], v[136:137], v[184:185], v[104:105]
    s_add_u32 m0, s90, 6144
    s_add_u32 s68, s89, 344064
    buffer_load_dwordx4 v20, s[60:63], s68 offen lds
    v_pk_fma_f32 v[138:139], v[138:139], v[186:187], v[106:107]
    s_waitcnt lgkmcnt(12)
    v_pk_fma_f32 v[140:141], v[140:141], v[188:189], v[108:109]
    v_pk_fma_f32 v[142:143], v[142:143], v[190:191], v[110:111]
    s_waitcnt lgkmcnt(9)
    v_pk_fma_f32 v[144:145], v[144:145], v[192:193], v[112:113]
    v_pk_fma_f32 v[146:147], v[146:147], v[194:195], v[114:115]
    s_waitcnt lgkmcnt(8)
    v_pk_fma_f32 v[148:149], v[148:149], v[196:197], v[116:117]
    v_pk_fma_f32 v[150:151], v[150:151], v[198:199], v[118:119]
    s_waitcnt lgkmcnt(4)
    v_pk_fma_f32 v[152:153], v[152:153], v[94:95], v[126:127] op_sel:[0,1,1] op_sel_hi:[1,0,0]
    v_pk_fma_f32 v[154:155], v[154:155], v[92:93], v[124:125] op_sel:[0,1,1] op_sel_hi:[1,0,0]
    v_pk_fma_f32 v[156:157], v[156:157], v[90:91], v[122:123] op_sel:[0,1,1] op_sel_hi:[1,0,0]
    v_pk_fma_f32 v[158:159], v[158:159], v[88:89], v[120:121] op_sel:[0,1,1] op_sel_hi:[1,0,0]
    s_waitcnt lgkmcnt(0)
    v_pk_fma_f32 v[160:161], v[160:161], v[102:103], v[134:135] op_sel:[0,1,1] op_sel_hi:[1,0,0]
    v_pk_fma_f32 v[162:163], v[162:163], v[100:101], v[132:133] op_sel:[0,1,1] op_sel_hi:[1,0,0]
    v_pk_fma_f32 v[164:165], v[164:165], v[98:99], v[130:131] op_sel:[0,1,1] op_sel_hi:[1,0,0]
    v_pk_fma_f32 v[166:167], v[166:167], v[96:97], v[128:129] op_sel:[0,1,1] op_sel_hi:[1,0,0]
    v_pk_add_f32 v[104:105], v[144:145], v[152:153]
    v_pk_add_f32 v[120:121], v[160:161], v[136:137]
    v_pk_add_f32 v[106:107], v[146:147], v[154:155]
    v_pk_add_f32 v[122:123], v[162:163], v[138:139]
    v_pk_add_f32 v[108:109], v[148:149], v[156:157]
    v_pk_add_f32 v[124:125], v[164:165], v[140:141]
    v_pk_add_f32 v[110:111], v[150:151], v[158:159]
    v_pk_add_f32 v[126:127], v[166:167], v[142:143]
    v_pk_fma_f32 v[104:105], v[120:121], s[10:11], v[104:105]
    v_pk_fma_f32 v[106:107], v[122:123], s[10:11], v[106:107]
    v_pk_fma_f32 v[108:109], v[124:125], s[10:11], v[108:109]
    v_pk_fma_f32 v[110:111], v[126:127], s[10:11], v[110:111]
    v_cvt_pk_bf16_f32 v184, v104, v105
    s_add_u32 m0, s90, 8192
    s_add_u32 s68, s89, 57344
    buffer_load_dwordx4 v19, s[60:63], s68 offen lds
    v_cvt_pk_bf16_f32 v185, v106, v107
    v_cvt_pk_bf16_f32 v186, v108, v109
    v_cvt_pk_bf16_f32 v187, v110, v111
    ds_write_b128 v45, v[184:187]
    v_pk_add_f32 v[112:113], v[144:145], v[152:153] neg_lo:[0,1] neg_hi:[0,1]
    v_pk_add_f32 v[128:129], v[160:161], v[136:137] neg_lo:[0,1] neg_hi:[0,1]
    v_pk_add_f32 v[114:115], v[146:147], v[154:155] neg_lo:[0,1] neg_hi:[0,1]
    v_pk_add_f32 v[130:131], v[162:163], v[138:139] neg_lo:[0,1] neg_hi:[0,1]
    v_pk_add_f32 v[116:117], v[148:149], v[156:157] neg_lo:[0,1] neg_hi:[0,1]
    v_pk_add_f32 v[132:133], v[164:165], v[140:141] neg_lo:[0,1] neg_hi:[0,1]
    v_pk_add_f32 v[118:119], v[150:151], v[158:159] neg_lo:[0,1] neg_hi:[0,1]
    v_pk_add_f32 v[134:135], v[166:167], v[142:143] neg_lo:[0,1] neg_hi:[0,1]
    v_pk_fma_f32 v[112:113], v[128:129], s[10:11], v[112:113] neg_lo:[1,0,0] neg_hi:[1,0,0]
    v_pk_fma_f32 v[114:115], v[130:131], s[10:11], v[114:115] neg_lo:[1,0,0] neg_hi:[1,0,0]
    v_pk_fma_f32 v[116:117], v[132:133], s[10:11], v[116:117] neg_lo:[1,0,0] neg_hi:[1,0,0]
    v_pk_fma_f32 v[118:119], v[134:135], s[10:11], v[118:119] neg_lo:[1,0,0] neg_hi:[1,0,0]
    v_cvt_pk_bf16_f32 v188, v112, v113
    v_cvt_pk_bf16_f32 v189, v114, v115
    v_cvt_pk_bf16_f32 v190, v116, v117
    v_cvt_pk_bf16_f32 v191, v118, v119
    ds_write_b128 v45, v[188:191] offset:4096
    s_waitcnt lgkmcnt(0)
    s_barrier
    ds_read_b128 v[104:107], v46 offset:0
    ds_read_b128 v[108:111], v47 offset:1024
    ds_read_b128 v[112:115], v46 offset:2048
    ds_read_b64 v[116:117], v48 offset:0
    ds_read_b128 v[118:121], v46 offset:4096
    ds_read_b128 v[122:125], v47 offset:5120
    ds_read_b128 v[126:129], v46 offset:6144
    ds_read_b64 v[130:131], v48 offset:4096
    s_waitcnt lgkmcnt(7)
    v_mfma_f32_16x16x32_bf16 v[184:187], v[104:107], v[242:245], 0
    s_add_u32 m0, s90, 10240
    s_add_u32 s68, s89, 86016
    buffer_load_dwordx4 v19, s[60:63], s68 offen lds
    v_mfma_f32_16x16x32_bf16 v[192:195], v[104:107], v[228:231], 0
    s_waitcnt lgkmcnt(3)
    v_mfma_f32_16x16x32_bf16 v[188:191], v[118:121], v[214:217], 0
    v_mfma_f32_16x16x32_bf16 v[196:199], v[118:121], v[200:203], 0
    v_mfma_f32_16x16x32_bf16 v[184:187], v[108:111], v[246:249], v[184:187]
    v_mfma_f32_16x16x32_bf16 v[192:195], v[108:111], v[232:235], v[192:195]
    s_waitcnt lgkmcnt(2)
    v_mfma_f32_16x16x32_bf16 v[188:191], v[122:125], v[218:221], v[188:191]
    v_mfma_f32_16x16x32_bf16 v[196:199], v[122:125], v[204:207], v[196:199]
    s_add_u32 m0, s90, 12288
    s_add_u32 s68, s89, 315392
    buffer_load_dwordx4 v20, s[60:63], s68 offen lds
    v_mfma_f32_16x16x32_bf16 v[184:187], v[112:115], v[250:253], v[184:187]
    v_mfma_f32_16x16x32_bf16 v[192:195], v[112:115], v[236:239], v[192:195]
    s_waitcnt lgkmcnt(1)
    v_mfma_f32_16x16x32_bf16 v[188:191], v[126:129], v[222:225], v[188:191]
    v_mfma_f32_16x16x32_bf16 v[196:199], v[126:129], v[208:211], v[196:199]
    s_nop 1
    v_mfma_f32_16x16x16_bf16 v[184:187], v[116:117], v[254:255], v[184:187]
    v_mfma_f32_16x16x16_bf16 v[192:195], v[116:117], v[240:241], v[192:195]
    s_waitcnt lgkmcnt(0)
    v_mfma_f32_16x16x16_bf16 v[188:191], v[130:131], v[226:227], v[188:191]
    s_add_u32 m0, s90, 14336
    s_add_u32 s68, s89, 286720
    buffer_load_dwordx4 v20, s[60:63], s68 offen lds
    v_mfma_f32_16x16x16_bf16 v[196:199], v[130:131], v[212:213], v[196:199]
    s_nop 0
    v_cvt_pk_bf16_f32 v88, v184, v185
    v_cvt_pk_bf16_f32 v89, v186, v187
    s_nop 0
    v_cvt_pk_bf16_f32 v90, v188, v189
    v_cvt_pk_bf16_f32 v91, v190, v191
    v_cvt_pk_bf16_f32 v92, v192, v193
    v_cvt_pk_bf16_f32 v93, v194, v195
    v_cvt_pk_bf16_f32 v94, v196, v197
    v_cvt_pk_bf16_f32 v95, v198, v199
    s_cmp_lg_u32 s88, 0
    s_cbranch_scc1 ad_reg_12
    v_mov_b32 v96, 0
    v_mov_b32 v97, 0
    v_mov_b32 v98, v90
    v_mov_b32 v99, v91
    v_cmp_eq_u32 vcc, 0, v2
    s_nop 0
    v_mfma_f32_16x16x32_bf16 v[120:123], v[34:37], v[96:99], 0
    v_mfma_f32_16x16x32_bf16 v[124:127], v[38:41], v[96:99], 0
    v_cndmask_b32 v90, v90, v96, vcc
    v_cndmask_b32 v91, v91, v96, vcc
    s_nop 4
    v_cvt_pk_bf16_f32 v100, v120, v121
    v_cvt_pk_bf16_f32 v101, v122, v123
    v_cvt_pk_bf16_f32 v102, v124, v125
    v_cvt_pk_bf16_f32 v103, v126, v127
    v_and_b32 v100, -2, v100
    buffer_store_dwordx4 v[100:103], v25, s[52:55], s79 offen sc1
ad_reg_12:
    v_mfma_f32_16x16x32_bf16 v[104:107], v[88:91], v[34:37], 0
    v_mfma_f32_16x16x32_bf16 v[108:111], v[88:91], v[38:41], 0
    v_mfma_f32_16x16x32_bf16 v[112:115], v[92:95], v[34:37], 0
    v_mfma_f32_16x16x32_bf16 v[116:119], v[92:95], v[38:41], 0
    s_nop 4
    v_cvt_pk_bf16_f32 v128, v104, v105
    v_cvt_pk_bf16_f32 v129, v106, v107
    v_cvt_pk_bf16_f32 v130, v108, v109
    v_cvt_pk_bf16_f32 v131, v110, v111
    v_and_b32 v128, -2, v128
    buffer_store_dwordx4 v[128:131], v24, s[52:55], s75 offen sc1
    v_cvt_pk_bf16_f32 v132, v112, v113
    v_cvt_pk_bf16_f32 v133, v114, v115
    v_cvt_pk_bf16_f32 v134, v116, v117
    v_cvt_pk_bf16_f32 v135, v118, v119
    v_and_b32 v132, -2, v132
    buffer_store_dwordx4 v[132:135], v24, s[52:55], s76 offen sc1
    buffer_load_dword v24, v33, s[52:55], s3 offen sc1
    buffer_load_dwordx2 v[34:35], v42, s[52:55], s3 offen sc1
    v_lshl_or_b32 v26, v27, 16, v26
    v_mov_b32 v27, v14
    v_cmp_gt_u32 vcc, 8, v0
    v_lshlrev_b32 v32, 3, v0
    s_nop 0
    v_cndmask_b32 v32, v8, v32, vcc
    s_lshl_b32 s25, s2, 6
    s_add_u32 s25, s25, 0x6000
    buffer_store_dwordx2 v[26:27], v32, s[52:55], s25 offen sc1
    s_cmp_ge_u32 s24, 56
    s_cbranch_scc1 ad_nop3_13
    v_lshlrev_b32 v17, 16, v17
    v_mul_f32 v6, 0xbfb8aa3b, v17
    v_exp_f32 v6, v6
    v_lshlrev_b32 v7, 1, v0
    v_add_f32 v6, 1.0, v6
    v_rcp_f32 v6, v6
    v_add_u32 v7, 158208, v7
    v_mul_f32 v17, v17, v6
    v_cvt_pk_bf16_f32 v17, v17, v17
    ds_write_b16 v7, v17
    v_bfe_u32 v6, v0, 2, 2
    v_lshl_add_u32 v7, v3, 3, v6
    v_lshl_add_u32 v6, v3, 2, v6
    v_and_b32 v36, 3, v0
    s_lshl_b32 s25, s22, 5
    s_add_u32 s25, s25, 94208
    v_lshl_add_u32 v36, v36, 3, s25
    v_lshl_add_u32 v7, v7, 7, v36
    v_lshl_add_u32 v6, v6, 7, v36
    v_lshlrev_b32 v37, 4, v3
    v_add_u32 v37, 158208, v37
    v_lshlrev_b32 v38, 3, v3
    v_add_u32 v38, 158400, v38
    s_waitcnt vmcnt(13) lgkmcnt(0)
    s_barrier
    ds_read_b128 v[228:231], v37 offset:0
    ds_read_b64_tr_b16 v[242:243], v7 offset:0
    ds_read_b64_tr_b16 v[244:245], v7 offset:512
    ds_read_b128 v[232:235], v37 offset:64
    ds_read_b64_tr_b16 v[246:247], v7 offset:4096
    ds_read_b64_tr_b16 v[248:249], v7 offset:4608
    ds_read_b128 v[236:239], v37 offset:128
    ds_read_b64_tr_b16 v[250:251], v7 offset:8192
    ds_read_b64_tr_b16 v[252:253], v7 offset:8704
    ds_read_b64 v[240:241], v38
    ds_read_b64_tr_b16 v[254:255], v6 offset:12288
    v_and_b32 v6, 0x33, v1
    v_cmp_eq_u32 vcc, 0, v6
    v_lshlrev_b32 v6, 2, v1
    s_nop 0
    v_cndmask_b32 v6, v8, v6, vcc
    s_mov_b32 s25, 0x07060503
    s_mov_b32 s26, 0x07060502
    s_mov_b32 s27, 0x07060501
    s_waitcnt lgkmcnt(8)
    v_mfma_f32_16x16x32_bf16 v[36:39], v[228:231], v[242:245], 0
    s_waitcnt lgkmcnt(5)
    v_mfma_f32_16x16x32_bf16 v[36:39], v[232:235], v[246:249], v[36:39]
    s_waitcnt lgkmcnt(2)
    v_mfma_f32_16x16x32_bf16 v[36:39], v[236:239], v[250:253], v[36:39]
    s_waitcnt lgkmcnt(0)
    s_nop 4
    v_mfma_f32_16x16x16_bf16 v[36:39], v[240:241], v[254:255], v[36:39]
    s_nop 7
    v_mov_b32_dpp v243, v36 quad_perm:[1,1,1,1] row_mask:0xf bank_mask:0xf
    v_mov_b32_dpp v244, v36 quad_perm:[2,2,2,2] row_mask:0xf bank_mask:0xf
    v_mov_b32_dpp v245, v36 quad_perm:[3,3,3,3] row_mask:0xf bank_mask:0xf
    v_perm_b32 v36, v36, v245, s25
    v_perm_b32 v37, v243, v245, s26
    v_perm_b32 v38, v244, v245, s27
    v_mov_b32 v39, v14
    buffer_store_dwordx4 v[36:39], v6, s[52:55], s33 offen sc1
    s_barrier
ad_nop3_13:
    s_mov_b32 s4, s18
    s_mov_b32 s5, s19
    s_mov_b32 s6, 0x1c0000
    s_mov_b32 s7, 0x20000
    s_lshr_b32 s10, s23, 1
    s_mul_i32 s10, s10, 28672
    s_and_b32 s26, s23, 1
    s_lshl_b32 s26, s26, 8
    s_add_u32 s10, s10, s26
    s_lshl_b32 s26, s34, 2
    s_add_u32 s26, s26, s22
    s_lshl_b32 s27, s26, 12
    s_add_u32 s10, s10, s27
    s_add_u32 s10, s10, 0x1e4000
    s_lshl_b32 s11, s35, 2
    s_add_u32 s11, s11, s22
    s_mul_i32 s11, s11, 114688
    s_lshl_b32 s25, s36, 11
    s_add_u32 s11, s11, s25
    s_add_u32 s11, s11, 0x3a4000
    v_lshlrev_b32 v18, 7, v0
    v_cmp_gt_u32 vcc, 8, v0
    s_nop 1
    v_cndmask_b32 v18, v8, v18, vcc
    v_lshrrev_b32 v6, 1, v2
    v_and_b32 v7, 1, v2
    v_lshlrev_b32 v7, 7, v7
    v_lshl_add_u32 v13, v6, 9, v7
    v_cmp_gt_u32 vcc, 16, v1
    s_nop 1
    v_cndmask_b32 v13, v8, v13, vcc
    v_mul_u32_u24 v16, 114688, v3
    v_lshl_add_u32 v16, v2, 7, v16
    v_cmp_gt_u32 vcc, 7, v2
    s_nop 1
    v_cndmask_b32 v16, v8, v16, vcc
    v_mul_u32_u24 v17, 28672, v3
    v_lshl_add_u32 v17, v2, 7, v17
    s_lshl_b32 s12, s22, 9
    s_add_u32 s12, s12, s23
    s_mul_i32 s12, s12, 896
    s_cmp_eq_u32 s34, 0
    s_cselect_b32 s25, s12, 0x40000000
    v_add_u32 v16, s25, v16
    s_and_b32 s13, s74, 7
    s_lshl_b32 s13, s13, 1
    s_bfe_u32 s14, s74, 0x10003
    s_add_u32 s13, s13, s14
    s_and_b32 s14, s74, 0xf0
    s_add_u32 s13, s13, s14
    s_lshl_b32 s13, s13, 6
    s_add_u32 s13, s13, 0x20000
    s_add_u32 s14, s13, 925696
    v_lshrrev_b32 v6, 2, v0
    v_mul_u32_u24 v25, 14464, v6
    v_and_b32 v6, 3, v0
    v_lshl_add_u32 v25, v6, 4, v25
    s_lshl_b32 s25, s22, 4
    v_add_u32 v6, s25, v2
    v_mul_u32_u24 v26, 14464, v6
    v_lshl_add_u32 v26, v3, 4, v26
    s_mov_b32 s40, s52
    s_mov_b32 s41, s53
    s_cmp_le_u32 s2, 224
    s_cselect_b32 s42, 0xdb4000, 0
    s_mov_b32 s43, 0x20000
    s_lshr_b32 s15, s2, 5
    s_mul_i32 s16, s15, 229376
    s_lshl_b32 s25, s22, 11
    s_add_u32 s16, s16, s25
    s_add_u32 s16, s16, 0xaa4000
    s_add_u32 s17, s16, 114688
    v_lshl_add_u32 v6, v2, 7, s23
    v_cvt_f32_u32 v27, v6
    v_mul_f32 v27, 0x3a000000, v27
    v_mul_f32 v32, v27, v9
    v_cos_f32 v216, v32
    v_sin_f32 v220, v32
    v_fmamk_f32 v6, v27, 0x41000000, v32
    v_cos_f32 v217, v6
    v_sin_f32 v221, v6
    v_fmamk_f32 v6, v27, 0x40800000, v32
    v_cos_f32 v218, v6
    v_sin_f32 v222, v6
    v_fmamk_f32 v6, v27, 0x41400000, v32
    v_cos_f32 v219, v6
    v_sin_f32 v223, v6
    v_cvt_pk_bf16_f32 v224, v216, -v220
    v_cvt_pk_bf16_f32 v228, v220, v216
    v_cvt_pk_bf16_f32 v225, v217, -v221
    v_cvt_pk_bf16_f32 v229, v221, v217
    v_cvt_pk_bf16_f32 v226, v218, -v222
    v_cvt_pk_bf16_f32 v230, v222, v218
    v_cvt_pk_bf16_f32 v227, v219, -v223
    v_cvt_pk_bf16_f32 v231, v223, v219
    v_bfe_u32 v7, v0, 3, 1
    v_lshlrev_b32 v36, 12, v7
    v_lshl_add_u32 v36, v7, 6, v36
    v_lshl_add_u32 v36, v3, 8, v36
    v_bfe_u32 v6, v0, 2, 1
    v_lshl_add_u32 v36, v6, 7, v36
    v_and_b32 v6, 3, v0
    v_lshl_add_u32 v36, v6, 4, v36
    v_and_b32 v6, 1, v3
    v_lshl_add_u32 v36, v6, 3, v36
    v_add_u32 v36, 114688, v36
    v_xor_b32 v37, 8, v36
    v_xor_b32 v38, 64, v36
    v_xor_b32 v39, 64, v37
    v_add_u32 v27, 122880, v4
    s_lshr_b32 s25, s22, 1
    s_lshl_b32 s25, s25, 10
    s_and_b32 s26, s22, 1
    s_lshl_b32 s26, s26, 3
    s_add_u32 s25, s25, s26
    v_add_u32 v32, s25, v27
    v_add_u32 v40, 114688, v5
    v_xor_b32 v41, 64, v40
    v_lshlrev_b32 v46, 31, v2
    v_or_b32 v46, 1.0, v46
    v_cmp_eq_u32 vcc, 0, v3
    s_lshl_b32 s25, s22, 5
    s_add_u32 s25, s25, 1
    v_lshl_add_u32 v6, v2, 1, s25
    v_cvt_f32_u32 v44, v6
    v_mul_f32 v44, 0x3a924925, v44
    v_mul_f32 v6, 0x41000000, v9
    v_mul_f32 v45, v44, v6
    v_cos_f32 v48, v44
    v_mul_f32 v47, 0x42000000, v44
    v_cos_f32 v50, v47
    v_add_f32 v48, v48, v48
    v_add_f32 v50, v50, v50
    v_cos_f32 v200, v45
    v_sin_f32 v201, v45
    v_fmamk_f32 v47, v44, 0x3f800000, v45
    v_cos_f32 v202, v47
    v_sin_f32 v203, v47
    s_nop 0
    v_pk_fma_f32 v[204:205], v[48:49], v[202:203], v[200:201] op_sel_hi:[0,1,1] neg_lo:[0,0,1] neg_hi:[0,0,1]
    v_pk_fma_f32 v[206:207], v[48:49], v[204:205], v[202:203] op_sel_hi:[0,1,1] neg_lo:[0,0,1] neg_hi:[0,0,1]
    v_pk_fma_f32 v[208:209], v[48:49], v[206:207], v[204:205] op_sel_hi:[0,1,1] neg_lo:[0,0,1] neg_hi:[0,0,1]
    v_pk_fma_f32 v[210:211], v[48:49], v[208:209], v[206:207] op_sel_hi:[0,1,1] neg_lo:[0,0,1] neg_hi:[0,0,1]
    v_pk_fma_f32 v[212:213], v[48:49], v[210:211], v[208:209] op_sel_hi:[0,1,1] neg_lo:[0,0,1] neg_hi:[0,0,1]
    v_pk_fma_f32 v[214:215], v[48:49], v[212:213], v[210:211] op_sel_hi:[0,1,1] neg_lo:[0,0,1] neg_hi:[0,0,1]
    v_cndmask_b32 v46, v201, v46, vcc
    v_cvt_pk_bf16_f32 v216, v200, v204
    v_cvt_pk_bf16_f32 v218, v202, v206
    v_cvt_pk_bf16_f32 v220, v46, v205
    v_cvt_pk_bf16_f32 v222, v203, v207
    v_cvt_pk_bf16_f32 v217, v208, v212
    v_cvt_pk_bf16_f32 v219, v210, v214
    v_cvt_pk_bf16_f32 v221, v209, v213
    v_cvt_pk_bf16_f32 v223, v211, v215
    v_accvgpr_write_b32 a64, v216
    v_accvgpr_write_b32 a65, v217
    v_accvgpr_write_b32 a78, v218
    v_accvgpr_write_b32 a79, v219
    v_accvgpr_write_b32 a92, v220
    v_accvgpr_write_b32 a93, v221
    v_accvgpr_write_b32 a106, v222
    v_accvgpr_write_b32 a107, v223
    v_fmamk_f32 v47, v44, 0x42000000, v45
    v_cos_f32 v184, v47
    v_sin_f32 v185, v47
    v_fmamk_f32 v47, v44, 0x42040000, v45
    v_cos_f32 v186, v47
    v_sin_f32 v187, v47
    s_nop 0
    v_pk_fma_f32 v[188:189], v[48:49], v[186:187], v[184:185] op_sel_hi:[0,1,1] neg_lo:[0,0,1] neg_hi:[0,0,1]
    v_pk_fma_f32 v[190:191], v[48:49], v[188:189], v[186:187] op_sel_hi:[0,1,1] neg_lo:[0,0,1] neg_hi:[0,0,1]
    v_pk_fma_f32 v[192:193], v[48:49], v[190:191], v[188:189] op_sel_hi:[0,1,1] neg_lo:[0,0,1] neg_hi:[0,0,1]
    v_pk_fma_f32 v[194:195], v[48:49], v[192:193], v[190:191] op_sel_hi:[0,1,1] neg_lo:[0,0,1] neg_hi:[0,0,1]
    v_pk_fma_f32 v[196:197], v[48:49], v[194:195], v[192:193] op_sel_hi:[0,1,1] neg_lo:[0,0,1] neg_hi:[0,0,1]
    v_pk_fma_f32 v[198:199], v[48:49], v[196:197], v[194:195] op_sel_hi:[0,1,1] neg_lo:[0,0,1] neg_hi:[0,0,1]
    v_cvt_pk_bf16_f32 v216, v184, v188
    v_cvt_pk_bf16_f32 v218, v186, v190
    v_cvt_pk_bf16_f32 v220, v185, v189
    v_cvt_pk_bf16_f32 v222, v187, v191
    v_cvt_pk_bf16_f32 v217, v192, v196
    v_cvt_pk_bf16_f32 v219, v194, v198
    v_cvt_pk_bf16_f32 v221, v193, v197
    v_cvt_pk_bf16_f32 v223, v195, v199
    v_accvgpr_write_b32 a66, v216
    v_accvgpr_write_b32 a67, v217
    v_accvgpr_write_b32 a80, v218
    v_accvgpr_write_b32 a81, v219
    v_accvgpr_write_b32 a94, v220
    v_accvgpr_write_b32 a95, v221
    v_accvgpr_write_b32 a108, v222
    v_accvgpr_write_b32 a109, v223
    v_pk_fma_f32 v[152:153], v[50:51], v[184:185], v[200:201] op_sel_hi:[0,1,1] neg_lo:[0,0,1] neg_hi:[0,0,1]
    v_pk_fma_f32 v[154:155], v[50:51], v[186:187], v[202:203] op_sel_hi:[0,1,1] neg_lo:[0,0,1] neg_hi:[0,0,1]
    v_pk_fma_f32 v[156:157], v[50:51], v[188:189], v[204:205] op_sel_hi:[0,1,1] neg_lo:[0,0,1] neg_hi:[0,0,1]
    v_pk_fma_f32 v[158:159], v[50:51], v[190:191], v[206:207] op_sel_hi:[0,1,1] neg_lo:[0,0,1] neg_hi:[0,0,1]
    v_pk_fma_f32 v[160:161], v[50:51], v[192:193], v[208:209] op_sel_hi:[0,1,1] neg_lo:[0,0,1] neg_hi:[0,0,1]
    v_pk_fma_f32 v[162:163], v[50:51], v[194:195], v[210:211] op_sel_hi:[0,1,1] neg_lo:[0,0,1] neg_hi:[0,0,1]
    v_pk_fma_f32 v[164:165], v[50:51], v[196:197], v[212:213] op_sel_hi:[0,1,1] neg_lo:[0,0,1] neg_hi:[0,0,1]
    v_pk_fma_f32 v[166:167], v[50:51], v[198:199], v[214:215] op_sel_hi:[0,1,1] neg_lo:[0,0,1] neg_hi:[0,0,1]
    v_cvt_pk_bf16_f32 v216, v152, v156
    v_cvt_pk_bf16_f32 v218, v154, v158
    v_cvt_pk_bf16_f32 v220, v153, v157
    v_cvt_pk_bf16_f32 v222, v155, v159
    v_cvt_pk_bf16_f32 v217, v160, v164
    v_cvt_pk_bf16_f32 v219, v162, v166
    v_cvt_pk_bf16_f32 v221, v161, v165
    v_cvt_pk_bf16_f32 v223, v163, v167
    v_accvgpr_write_b32 a68, v216
    v_accvgpr_write_b32 a69, v217
    v_accvgpr_write_b32 a82, v218
    v_accvgpr_write_b32 a83, v219
    v_accvgpr_write_b32 a96, v220
    s_mov_b32 s28, 100000
ad_lp_15:
    s_waitcnt vmcnt(1)
    v_xor_b32 v24, v24, v14
    s_waitcnt vmcnt(0)
    v_xor_b32 v34, v34, v43
    v_or_b32 v24, v24, v34
    v_cmp_ne_u32 s[32:33], 0, v24
    s_nop 3
    s_cmp_eq_u64 s[32:33], 0
    s_cbranch_scc1 ad_ok_14
    s_sleep 4
    buffer_load_dword v24, v33, s[52:55], s3 offen sc1
    buffer_load_dwordx2 v[34:35], v42, s[52:55], s3 offen sc1
    s_sub_u32 s28, s28, 1
    s_cmp_lg_u32 s28, 0
    s_cbranch_scc1 ad_lp_15
ad_ok_14:
    ds_read_u16 v248, v23 offset:0
    ds_read_u16 v240, v23 offset:1024
    ds_read_u16 v249, v23 offset:64
    ds_read_u16 v241, v23 offset:1088
    ds_read_u16 v250, v23 offset:128
    ds_read_u16 v242, v23 offset:1152
    ds_read_u16 v251, v23 offset:192
    ds_read_u16 v243, v23 offset:1216
    ds_read_u16 v252, v23 offset:2048
    ds_read_u16 v244, v23 offset:3072
    ds_read_u16 v253, v23 offset:2112
    ds_read_u16 v245, v23 offset:3136
    ds_read_u16 v254, v23 offset:2176
    ds_read_u16 v246, v23 offset:3200
    ds_read_u16 v255, v23 offset:2240
    ds_read_u16 v247, v23 offset:3264
    s_waitcnt lgkmcnt(0)
    s_barrier
    buffer_load_dwordx4 v[232:235], v25, s[52:55], s13 offen sc1
    buffer_load_dwordx4 v[236:239], v25, s[52:55], s14 offen sc1
    ds_read_b64_tr_b16 v[144:145], v28 offset:0
    ds_read_b64_tr_b16 v[146:147], v28 offset:512
    ds_read_b64_tr_b16 v[148:149], v28 offset:64
    ds_read_b64_tr_b16 v[150:151], v28 offset:576
    s_waitcnt lgkmcnt(2)
    buffer_store_dwordx4 v[144:147], v4, s[56:59], s70 offen sc1
    s_waitcnt lgkmcnt(0)
    buffer_store_dwordx4 v[148:151], v4, s[56:59], s71 offen sc1
    s_lshl_b32 s68, s35, 8
    s_add_u32 s68, s68, 0x1000
    buffer_load_dword a252, v10, s[52:55], s68 offen
    buffer_load_dword a254, v10, s[52:55], s68 offen offset:128
    s_lshl_b32 s68, s35, 10
    s_add_u32 s68, s68, 0x2000
    buffer_load_dword a253, v18, s[52:55], s68 offen
    s_waitcnt vmcnt(7)
    v_cmp_ne_u32 s[32:33], v35, v15
    s_nop 3
    s_cmp_lg_u32 s32, 0
    s_cselect_b32 s24, 1, 0
    s_add_u32 m0, s90, 16384
    s_add_u32 s68, s89, 114688
    buffer_load_dwordx4 v19, s[60:63], s68 offen lds
    s_add_u32 m0, s90, 18432
    s_add_u32 s68, s89, 143360
    buffer_load_dwordx4 v19, s[60:63], s68 offen lds
    s_add_u32 m0, s90, 20480
    s_add_u32 s68, s89, 258048
    buffer_load_dwordx4 v20, s[60:63], s68 offen lds
    s_add_u32 m0, s90, 22528
    s_add_u32 s68, s89, 229376
    buffer_load_dwordx4 v20, s[60:63], s68 offen lds
    s_add_u32 m0, s90, 24576
    s_add_u32 s68, s89, 172032
    buffer_load_dwordx4 v19, s[60:63], s68 offen lds
    s_add_u32 m0, s90, 26624
    s_add_u32 s68, s89, 200704
    buffer_load_dwordx4 v19, s[60:63], s68 offen lds
    s_add_u32 m0, s90, 28672
    s_add_u32 s68, s89, 200704
    buffer_load_dwordx4 v20, s[60:63], s68 offen lds
    s_add_u32 m0, s90, 30720
    s_add_u32 s68, s89, 172032
    buffer_load_dwordx4 v20, s[60:63], s68 offen lds
    s_add_u32 m0, s90, 32768
    s_add_u32 s68, s89, 229376
    buffer_load_dwordx4 v19, s[60:63], s68 offen lds
    v_accvgpr_write_b32 a97, v221
    v_accvgpr_write_b32 a110, v222
    v_accvgpr_write_b32 a111, v223
    v_pk_fma_f32 v[200:201], v[50:51], v[152:153], v[184:185] op_sel_hi:[0,1,1] neg_lo:[0,0,1] neg_hi:[0,0,1]
    v_pk_fma_f32 v[202:203], v[50:51], v[154:155], v[186:187] op_sel_hi:[0,1,1] neg_lo:[0,0,1] neg_hi:[0,0,1]
    v_pk_fma_f32 v[204:205], v[50:51], v[156:157], v[188:189] op_sel_hi:[0,1,1] neg_lo:[0,0,1] neg_hi:[0,0,1]
    v_pk_fma_f32 v[206:207], v[50:51], v[158:159], v[190:191] op_sel_hi:[0,1,1] neg_lo:[0,0,1] neg_hi:[0,0,1]
    v_pk_fma_f32 v[208:209], v[50:51], v[160:161], v[192:193] op_sel_hi:[0,1,1] neg_lo:[0,0,1] neg_hi:[0,0,1]
    v_pk_fma_f32 v[210:211], v[50:51], v[162:163], v[194:195] op_sel_hi:[0,1,1] neg_lo:[0,0,1] neg_hi:[0,0,1]
    v_pk_fma_f32 v[212:213], v[50:51], v[164:165], v[196:197] op_sel_hi:[0,1,1] neg_lo:[0,0,1] neg_hi:[0,0,1]
    v_pk_fma_f32 v[214:215], v[50:51], v[166:167], v[198:199] op_sel_hi:[0,1,1] neg_lo:[0,0,1] neg_hi:[0,0,1]
    v_cvt_pk_bf16_f32 v216, v200, v204
    v_cvt_pk_bf16_f32 v218, v202, v206
    v_cvt_pk_bf16_f32 v220, v201, v205
    v_cvt_pk_bf16_f32 v222, v203, v207
    v_cvt_pk_bf16_f32 v217, v208, v212
    v_cvt_pk_bf16_f32 v219, v210, v214
    v_cvt_pk_bf16_f32 v221, v209, v213
    v_cvt_pk_bf16_f32 v223, v211, v215
    v_accvgpr_write_b32 a70, v216
    v_accvgpr_write_b32 a71, v217
    v_accvgpr_write_b32 a84, v218
    v_accvgpr_write_b32 a85, v219
    v_accvgpr_write_b32 a98, v220
    v_accvgpr_write_b32 a99, v221
    v_accvgpr_write_b32 a112, v222
    v_accvgpr_write_b32 a113, v223
    v_pk_fma_f32 v[184:185], v[50:51], v[200:201], v[152:153] op_sel_hi:[0,1,1] neg_lo:[0,0,1] neg_hi:[0,0,1]
    v_pk_fma_f32 v[186:187], v[50:51], v[202:203], v[154:155] op_sel_hi:[0,1,1] neg_lo:[0,0,1] neg_hi:[0,0,1]
    v_pk_fma_f32 v[188:189], v[50:51], v[204:205], v[156:157] op_sel_hi:[0,1,1] neg_lo:[0,0,1] neg_hi:[0,0,1]
    v_pk_fma_f32 v[190:191], v[50:51], v[206:207], v[158:159] op_sel_hi:[0,1,1] neg_lo:[0,0,1] neg_hi:[0,0,1]
    v_pk_fma_f32 v[192:193], v[50:51], v[208:209], v[160:161] op_sel_hi:[0,1,1] neg_lo:[0,0,1] neg_hi:[0,0,1]
    v_pk_fma_f32 v[194:195], v[50:51], v[210:211], v[162:163] op_sel_hi:[0,1,1] neg_lo:[0,0,1] neg_hi:[0,0,1]
    v_pk_fma_f32 v[196:197], v[50:51], v[212:213], v[164:165] op_sel_hi:[0,1,1] neg_lo:[0,0,1] neg_hi:[0,0,1]
    v_pk_fma_f32 v[198:199], v[50:51], v[214:215], v[166:167] op_sel_hi:[0,1,1] neg_lo:[0,0,1] neg_hi:[0,0,1]
    v_cvt_pk_bf16_f32 v216, v184, v188
    v_cvt_pk_bf16_f32 v218, v186, v190
    v_cvt_pk_bf16_f32 v220, v185, v189
    v_cvt_pk_bf16_f32 v222, v187, v191
    v_cvt_pk_bf16_f32 v217, v192, v196
    v_cvt_pk_bf16_f32 v219, v194, v198
    v_cvt_pk_bf16_f32 v221, v193, v197
    v_cvt_pk_bf16_f32 v223, v195, v199
    v_accvgpr_write_b32 a72, v216
    v_accvgpr_write_b32 a73, v217
    v_accvgpr_write_b32 a86, v218
    v_accvgpr_write_b32 a87, v219
    v_accvgpr_write_b32 a100, v220
    v_accvgpr_write_b32 a101, v221
    v_accvgpr_write_b32 a114, v222
    v_accvgpr_write_b32 a115, v223
    v_pk_fma_f32 v[152:153], v[50:51], v[184:185], v[200:201] op_sel_hi:[0,1,1] neg_lo:[0,0,1] neg_hi:[0,0,1]
    v_pk_fma_f32 v[154:155], v[50:51], v[186:187], v[202:203] op_sel_hi:[0,1,1] neg_lo:[0,0,1] neg_hi:[0,0,1]
    v_pk_fma_f32 v[156:157], v[50:51], v[188:189], v[204:205] op_sel_hi:[0,1,1] neg_lo:[0,0,1] neg_hi:[0,0,1]
    v_pk_fma_f32 v[158:159], v[50:51], v[190:191], v[206:207] op_sel_hi:[0,1,1] neg_lo:[0,0,1] neg_hi:[0,0,1]
    v_pk_fma_f32 v[160:161], v[50:51], v[192:193], v[208:209] op_sel_hi:[0,1,1] neg_lo:[0,0,1] neg_hi:[0,0,1]
    v_pk_fma_f32 v[162:163], v[50:51], v[194:195], v[210:211] op_sel_hi:[0,1,1] neg_lo:[0,0,1] neg_hi:[0,0,1]
    v_pk_fma_f32 v[164:165], v[50:51], v[196:197], v[212:213] op_sel_hi:[0,1,1] neg_lo:[0,0,1] neg_hi:[0,0,1]
    v_pk_fma_f32 v[166:167], v[50:51], v[198:199], v[214:215] op_sel_hi:[0,1,1] neg_lo:[0,0,1] neg_hi:[0,0,1]
    v_cvt_pk_bf16_f32 v216, v152, v156
    v_cvt_pk_bf16_f32 v218, v154, v158
    v_cvt_pk_bf16_f32 v220, v153, v157
    v_cvt_pk_bf16_f32 v222, v155, v159
    v_cvt_pk_bf16_f32 v217, v160, v164
    v_cvt_pk_bf16_f32 v219, v162, v166
    v_cvt_pk_bf16_f32 v221, v161, v165
    v_cvt_pk_bf16_f32 v223, v163, v167
    v_accvgpr_write_b32 a74, v216
    v_accvgpr_write_b32 a75, v217
    v_accvgpr_write_b32 a88, v218
    v_accvgpr_write_b32 a89, v219
    v_accvgpr_write_b32 a102, v220
    v_accvgpr_write_b32 a103, v221
    v_accvgpr_write_b32 a116, v222
    v_accvgpr_write_b32 a117, v223
    v_pk_fma_f32 v[200:201], v[50:51], v[152:153], v[184:185] op_sel_hi:[0,1,1] neg_lo:[0,0,1] neg_hi:[0,0,1]
    v_pk_fma_f32 v[202:203], v[50:51], v[154:155], v[186:187] op_sel_hi:[0,1,1] neg_lo:[0,0,1] neg_hi:[0,0,1]
    v_pk_fma_f32 v[204:205], v[50:51], v[156:157], v[188:189] op_sel_hi:[0,1,1] neg_lo:[0,0,1] neg_hi:[0,0,1]
    v_pk_fma_f32 v[206:207], v[50:51], v[158:159], v[190:191] op_sel_hi:[0,1,1] neg_lo:[0,0,1] neg_hi:[0,0,1]
    v_pk_fma_f32 v[208:209], v[50:51], v[160:161], v[192:193] op_sel_hi:[0,1,1] neg_lo:[0,0,1] neg_hi:[0,0,1]
    v_pk_fma_f32 v[210:211], v[50:51], v[162:163], v[194:195] op_sel_hi:[0,1,1] neg_lo:[0,0,1] neg_hi:[0,0,1]
    v_pk_fma_f32 v[212:213], v[50:51], v[164:165], v[196:197] op_sel_hi:[0,1,1] neg_lo:[0,0,1] neg_hi:[0,0,1]
    v_pk_fma_f32 v[214:215], v[50:51], v[166:167], v[198:199] op_sel_hi:[0,1,1] neg_lo:[0,0,1] neg_hi:[0,0,1]
    v_cvt_pk_bf16_f32 v216, v200, v204
    v_cvt_pk_bf16_f32 v218, v202, v206
    v_cvt_pk_bf16_f32 v220, v201, v205
    v_cvt_pk_bf16_f32 v222, v203, v207
    v_cvt_pk_bf16_f32 v217, v208, v212
    v_cvt_pk_bf16_f32 v219, v210, v214
    v_cvt_pk_bf16_f32 v221, v209, v213
    v_cvt_pk_bf16_f32 v223, v211, v215
    v_accvgpr_write_b32 a76, v216
    v_accvgpr_write_b32 a77, v217
    v_accvgpr_write_b32 a90, v218
    v_accvgpr_write_b32 a91, v219
    v_accvgpr_write_b32 a104, v220
    v_accvgpr_write_b32 a105, v221
    v_accvgpr_write_b32 a118, v222
    v_accvgpr_write_b32 a119, v223
    v_lshlrev_b32 v248, 16, v248
    v_lshlrev_b32 v240, 16, v240
    v_mul_f32 v248, v248, v22
    v_mul_f32 v240, v240, v22
    v_lshlrev_b32 v249, 16, v249
    v_lshlrev_b32 v241, 16, v241
    v_mul_f32 v249, v249, v22
    v_mul_f32 v241, v241, v22
    v_lshlrev_b32 v250, 16, v250
    v_lshlrev_b32 v242, 16, v242
    v_mul_f32 v250, v250, v22
    v_mul_f32 v242, v242, v22
    v_lshlrev_b32 v251, 16, v251
    v_lshlrev_b32 v243, 16, v243
    v_mul_f32 v251, v251, v22
    v_mul_f32 v243, v243, v22
    v_lshlrev_b32 v252, 16, v252
    v_lshlrev_b32 v244, 16, v244
    v_mul_f32 v252, v252, v22
    v_mul_f32 v244, v244, v22
    v_lshlrev_b32 v253, 16, v253
    v_lshlrev_b32 v245, 16, v245
    v_mul_f32 v253, v253, v22
    v_mul_f32 v245, v245, v22
    v_lshlrev_b32 v254, 16, v254
    v_lshlrev_b32 v246, 16, v246
    v_mul_f32 v254, v254, v22
    v_mul_f32 v246, v246, v22
    v_lshlrev_b32 v255, 16, v255
    v_lshlrev_b32 v247, 16, v247
    v_mul_f32 v255, v255, v22
    v_mul_f32 v247, v247, v22
    s_cmp_lg_u32 s2, 224
    s_cbranch_scc1 ad_nq_16
    v_lshrrev_b32 v23, 1, v2
    v_and_b32 v6, 1, v2
    v_lshl_add_u32 v23, v6, 3, v23
    v_lshlrev_b32 v23, 3, v23
    v_lshl_add_u32 v23, v3, 9, v23
    s_lshl_b32 s26, s22, 11
    s_add_u32 s26, s26, 0x6000
    s_add_u32 s27, s26, 8192
    s_mov_b32 s28, 100000
ad_poll_17:
    buffer_load_dwordx2 v[208:209], v23, s[52:55], s26 offen offset:0 sc1
    buffer_load_dwordx2 v[210:211], v23, s[52:55], s26 offen offset:128 sc1
    buffer_load_dwordx2 v[212:213], v23, s[52:55], s26 offen offset:256 sc1
    buffer_load_dwordx2 v[214:215], v23, s[52:55], s26 offen offset:384 sc1
    buffer_load_dwordx2 v[216:217], v23, s[52:55], s27 offen offset:0 sc1
    buffer_load_dwordx2 v[218:219], v23, s[52:55], s27 offen offset:128 sc1
    buffer_load_dwordx2 v[220:221], v23, s[52:55], s27 offen offset:256 sc1
    buffer_load_dwordx2 v[222:223], v23, s[52:55], s27 offen offset:384 sc1
    s_waitcnt vmcnt(5)
    v_min3_u32 v6, v209, v211, v213
    v_max3_u32 v7, v209, v211, v213
    s_waitcnt vmcnt(3)
    v_min3_u32 v6, v6, v215, v217
    v_max3_u32 v7, v7, v215, v217
    s_waitcnt vmcnt(1)
    v_min3_u32 v6, v6, v219, v221
    v_max3_u32 v7, v7, v219, v221
    s_waitcnt vmcnt(0)
    v_min3_u32 v6, v6, v223, v223
    v_max3_u32 v7, v7, v223, v223
    v_xor_b32 v6, v6, v14
    v_xor_b32 v7, v7, v14
    v_or_b32 v6, v6, v7
    v_cmp_ne_u32 vcc, 0, v6
    s_nop 4
    s_cbranch_vccz ad_ok_18
    s_sleep 4
    s_sub_u32 s28, s28, 1
    s_cmp_lg_u32 s28, 0
    s_cbranch_scc1 ad_poll_17
ad_ok_18:
    v_and_b32 v240, 0xffff0000, v208
    v_lshlrev_b32 v248, 16, v208
    v_mul_f32 v248, v248, v22
    v_mul_f32 v240, v240, v22
    v_and_b32 v241, 0xffff0000, v210
    v_lshlrev_b32 v249, 16, v210
    v_mul_f32 v249, v249, v22
    v_mul_f32 v241, v241, v22
    v_and_b32 v242, 0xffff0000, v212
    v_lshlrev_b32 v250, 16, v212
    v_mul_f32 v250, v250, v22
    v_mul_f32 v242, v242, v22
    v_and_b32 v243, 0xffff0000, v214
    v_lshlrev_b32 v251, 16, v214
    v_mul_f32 v251, v251, v22
    v_mul_f32 v243, v243, v22
    v_and_b32 v244, 0xffff0000, v216
    v_lshlrev_b32 v252, 16, v216
    v_mul_f32 v252, v252, v22
    v_mul_f32 v244, v244, v22
    v_and_b32 v245, 0xffff0000, v218
    v_lshlrev_b32 v253, 16, v218
    v_mul_f32 v253, v253, v22
    v_mul_f32 v245, v245, v22
    v_and_b32 v246, 0xffff0000, v220
    v_lshlrev_b32 v254, 16, v220
    v_mul_f32 v254, v254, v22
    v_mul_f32 v246, v246, v22
    v_and_b32 v247, 0xffff0000, v222
    v_lshlrev_b32 v255, 16, v222
    v_mul_f32 v255, v255, v22
    v_mul_f32 v247, v247, v22
ad_nq_16:
    s_mov_b32 s3, 0x1a000
    v_cmp_gt_u32 vcc, 196, v0
    s_nop 1
    v_cndmask_b32 v33, v8, v33, vcc
    v_cndmask_b32 v43, 0, v14, vcc
    s_mov_b32 s28, 100001
    s_waitcnt vmcnt(14)
    v_max_u32 v6, v232, v236
    v_cmp_eq_u32 vcc, -1, v6
    s_nop 4
    s_cbranch_vccz ad_ok_21
    s_mov_b32 s28, 100000
ad_poll_22:
    buffer_load_dwordx4 v[232:235], v25, s[52:55], s13 offen sc1
    buffer_load_dwordx4 v[236:239], v25, s[52:55], s14 offen sc1
    s_waitcnt vmcnt(0)
    v_max_u32 v6, v232, v236
    v_cmp_eq_u32 vcc, -1, v6
    s_nop 4
    s_cbranch_vccz ad_ok_23
    s_sleep 4
    s_sub_u32 s28, s28, 1
    s_cmp_lg_u32 s28, 0
    s_cbranch_scc1 ad_poll_22
ad_ok_23:
ad_ok_21:
    ds_write_b128 v40, v[232:235]
    ds_write_b128 v41, v[236:239] offset:4096
    s_waitcnt lgkmcnt(0)
    s_barrier
    ds_read_b64_tr_b16 v[136:137], v36 offset:0
    ds_read_b64_tr_b16 v[138:139], v36 offset:1024
    ds_read_b64_tr_b16 v[152:153], v37 offset:0
    ds_read_b64_tr_b16 v[154:155], v37 offset:1024
    ds_read_b64_tr_b16 v[140:141], v36 offset:2048
    ds_read_b64_tr_b16 v[142:143], v36 offset:3072
    ds_read_b64_tr_b16 v[156:157], v37 offset:2048
    ds_read_b64_tr_b16 v[158:159], v37 offset:3072
    ds_read_b64_tr_b16 v[144:145], v38 offset:0
    ds_read_b64_tr_b16 v[146:147], v38 offset:1024
    ds_read_b64_tr_b16 v[160:161], v39 offset:0
    ds_read_b64_tr_b16 v[162:163], v39 offset:1024
    ds_read_b64_tr_b16 v[148:149], v38 offset:2048
    ds_read_b64_tr_b16 v[150:151], v38 offset:3072
    ds_read_b64_tr_b16 v[164:165], v39 offset:2048
    ds_read_b64_tr_b16 v[166:167], v39 offset:3072
    s_waitcnt lgkmcnt(14)
    v_mfma_f32_16x16x32_bf16 v[128:131], a[48:51], v[136:139], 0
    s_add_u32 m0, s90, 34816
    s_add_u32 s68, s89, 258048
    buffer_load_dwordx4 v19, s[60:63], s68 offen lds
    v_mfma_f32_16x16x32_bf16 v[232:235], a[32:35], v[136:139], 0
    s_waitcnt lgkmcnt(12)
    v_mfma_f32_16x16x32_bf16 v[184:187], a[32:35], v[152:155], 0
    v_mfma_f32_16x16x32_bf16 v[232:235], a[48:51], v[152:155], v[232:235]
    s_waitcnt lgkmcnt(10)
    v_mfma_f32_16x16x32_bf16 v[128:131], a[52:55], v[140:143], v[128:131]
    s_add_u32 m0, s90, 36864
    s_add_u32 s68, s89, 143360
    buffer_load_dwordx4 v20, s[60:63], s68 offen lds
    v_mfma_f32_16x16x32_bf16 v[232:235], a[36:39], v[140:143], v[232:235]
    s_waitcnt lgkmcnt(8)
    v_mfma_f32_16x16x32_bf16 v[184:187], a[36:39], v[156:159], v[184:187]
    v_mfma_f32_16x16x32_bf16 v[232:235], a[52:55], v[156:159], v[232:235]
    s_waitcnt lgkmcnt(6)
    v_mfma_f32_16x16x32_bf16 v[132:135], a[56:59], v[144:147], 0
    s_add_u32 m0, s90, 38912
    s_add_u32 s68, s89, 114688
    buffer_load_dwordx4 v20, s[60:63], s68 offen lds
    v_mfma_f32_16x16x32_bf16 v[236:239], a[40:43], v[144:147], 0
    s_waitcnt lgkmcnt(4)
    v_mfma_f32_16x16x32_bf16 v[188:191], a[40:43], v[160:163], 0
    v_mfma_f32_16x16x32_bf16 v[236:239], a[56:59], v[160:163], v[236:239]
    s_waitcnt lgkmcnt(2)
    v_mfma_f32_16x16x32_bf16 v[132:135], a[60:63], v[148:151], v[132:135]
    s_add_u32 m0, s90, 40960
    s_add_u32 s68, s89, 286720
    buffer_load_dwordx4 v19, s[60:63], s68 offen lds
    v_mfma_f32_16x16x32_bf16 v[236:239], a[44:47], v[148:151], v[236:239]
    s_waitcnt lgkmcnt(0)
    v_mfma_f32_16x16x32_bf16 v[188:191], a[44:47], v[164:167], v[188:191]
    v_mfma_f32_16x16x32_bf16 v[236:239], a[60:63], v[164:167], v[236:239]
    v_pk_add_f32 v[184:185], v[184:185], v[128:129] neg_lo:[0,1] neg_hi:[0,1]
    v_pk_add_f32 v[186:187], v[186:187], v[130:131] neg_lo:[0,1] neg_hi:[0,1]
    s_nop 4
    v_pk_add_f32 v[188:189], v[188:189], v[132:133] neg_lo:[0,1] neg_hi:[0,1]
    s_add_u32 m0, s90, 43008
    s_add_u32 s68, s89, 315392
    buffer_load_dwordx4 v19, s[60:63], s68 offen lds
    v_pk_add_f32 v[190:191], v[190:191], v[134:135] neg_lo:[0,1] neg_hi:[0,1]
    v_pk_add_f32 v[128:129], v[184:185], v[188:189]
    v_pk_add_f32 v[132:133], v[184:185], v[188:189] neg_lo:[0,1] neg_hi:[0,1]
    v_pk_add_f32 v[130:131], v[186:187], v[190:191]
    v_pk_add_f32 v[134:135], v[186:187], v[190:191] neg_lo:[0,1] neg_hi:[0,1]
    v_pk_add_f32 v[184:185], v[232:233], v[236:237]
    v_pk_add_f32 v[188:189], v[232:233], v[236:237] neg_lo:[0,1] neg_hi:[0,1]
    v_pk_add_f32 v[186:187], v[234:235], v[238:239]
    v_pk_add_f32 v[190:191], v[234:235], v[238:239] neg_lo:[0,1] neg_hi:[0,1]
    v_pk_mul_f32 v[112:113], v[184:185], v[248:249]
    v_pk_mul_f32 v[120:121], v[184:185], v[240:241]
    v_pk_mul_f32 v[114:115], v[186:187], v[250:251]
    v_pk_mul_f32 v[122:123], v[186:187], v[242:243]
    v_pk_mul_f32 v[116:117], v[188:189], v[252:253]
    v_pk_mul_f32 v[124:125], v[188:189], v[244:245]
    s_add_u32 m0, s90, 45056
    s_add_u32 s68, s89, 86016
    buffer_load_dwordx4 v20, s[60:63], s68 offen lds
    v_pk_mul_f32 v[118:119], v[190:191], v[254:255]
    v_pk_mul_f32 v[126:127], v[190:191], v[246:247]
    v_pk_fma_f32 v[112:113], v[128:129], v[240:241], v[112:113] neg_lo:[1,0,0] neg_hi:[1,0,0]
    v_pk_fma_f32 v[120:121], v[128:129], v[248:249], v[120:121]
    v_pk_fma_f32 v[114:115], v[130:131], v[242:243], v[114:115] neg_lo:[1,0,0] neg_hi:[1,0,0]
    v_pk_fma_f32 v[122:123], v[130:131], v[250:251], v[122:123]
    v_pk_fma_f32 v[116:117], v[132:133], v[244:245], v[116:117] neg_lo:[1,0,0] neg_hi:[1,0,0]
    v_pk_fma_f32 v[124:125], v[132:133], v[252:253], v[124:125]
    v_pk_fma_f32 v[118:119], v[134:135], v[246:247], v[118:119] neg_lo:[1,0,0] neg_hi:[1,0,0]
    v_pk_fma_f32 v[126:127], v[134:135], v[254:255], v[126:127]
    v_cvt_pk_bf16_f32 v232, v112, v114
    v_cvt_pk_bf16_f32 v233, v116, v118
    ds_write_b64 v32, v[232:233] offset:0
    v_cvt_pk_bf16_f32 v234, v113, v115
    v_cvt_pk_bf16_f32 v235, v117, v119
    s_add_u32 m0, s90, 47104
    s_add_u32 s68, s89, 57344
    buffer_load_dwordx4 v20, s[60:63], s68 offen lds
    ds_write_b64 v32, v[234:235] offset:2048
    v_cvt_pk_bf16_f32 v236, v120, v122
    v_cvt_pk_bf16_f32 v237, v124, v126
    ds_write_b64 v32, v[236:237] offset:4096
    v_cvt_pk_bf16_f32 v238, v121, v123
    v_cvt_pk_bf16_f32 v239, v125, v127
    ds_write_b64 v32, v[238:239] offset:6144
    s_waitcnt vmcnt(19) lgkmcnt(0)
    s_barrier
    buffer_store_dword v14, v10, s[52:55], s38 offen sc1
    ds_read_b128 v[136:139], v27 offset:0
    ds_read_b128 v[152:155], v27 offset:4096
    ds_read_b128 v[140:143], v27 offset:1024
    ds_read_b128 v[156:159], v27 offset:5120
    ds_read_b128 v[144:147], v27 offset:2048
    ds_read_b128 v[160:163], v27 offset:6144
    ds_read_b128 v[148:151], v27 offset:3072
    ds_read_b128 v[164:167], v27 offset:7168
    s_waitcnt lgkmcnt(7)
    v_mfma_f32_16x16x32_bf16 v[184:187], v[136:139], a[32:35], 0
    s_add_u32 m0, s90, 49152
    s_add_u32 s68, s89, 344064
    buffer_load_dwordx4 v19, s[60:63], s68 offen lds
    v_mfma_f32_16x16x32_bf16 v[232:235], v[136:139], a[48:51], 0
    s_waitcnt lgkmcnt(6)
    v_mfma_f32_16x16x32_bf16 v[128:131], v[152:155], a[48:51], 0
    v_mfma_f32_16x16x32_bf16 v[232:235], v[152:155], a[32:35], v[232:235]
    s_waitcnt lgkmcnt(5)
    v_mfma_f32_16x16x32_bf16 v[184:187], v[140:143], a[36:39], v[184:187]
    s_add_u32 m0, s90, 51200
    s_add_u32 s68, s89, 372736
    buffer_load_dwordx4 v19, s[60:63], s68 offen lds
    v_mfma_f32_16x16x32_bf16 v[232:235], v[140:143], a[52:55], v[232:235]
    s_waitcnt lgkmcnt(4)
    v_mfma_f32_16x16x32_bf16 v[128:131], v[156:159], a[52:55], v[128:131]
    v_mfma_f32_16x16x32_bf16 v[232:235], v[156:159], a[36:39], v[232:235]
    s_waitcnt lgkmcnt(3)
    v_mfma_f32_16x16x32_bf16 v[188:191], v[144:147], a[40:43], 0
    s_add_u32 m0, s90, 53248
    s_add_u32 s68, s89, 28672
    buffer_load_dwordx4 v20, s[60:63], s68 offen lds
    v_mfma_f32_16x16x32_bf16 v[236:239], v[144:147], a[56:59], 0
    s_waitcnt lgkmcnt(2)
    v_mfma_f32_16x16x32_bf16 v[132:135], v[160:163], a[56:59], 0
    v_mfma_f32_16x16x32_bf16 v[236:239], v[160:163], a[40:43], v[236:239]
    s_waitcnt lgkmcnt(1)
    v_mfma_f32_16x16x32_bf16 v[188:191], v[148:151], a[44:47], v[188:191]
    s_add_u32 m0, s90, 55296
    s_add_u32 s68, s89, 0
    buffer_load_dwordx4 v20, s[60:63], s68 offen lds
    v_mfma_f32_16x16x32_bf16 v[236:239], v[148:151], a[60:63], v[236:239]
    s_waitcnt lgkmcnt(0)
    v_mfma_f32_16x16x32_bf16 v[132:135], v[164:167], a[60:63], v[132:135]
    v_mfma_f32_16x16x32_bf16 v[236:239], v[164:167], a[44:47], v[236:239]
    v_pk_add_f32 v[184:185], v[184:185], v[128:129] neg_lo:[0,1] neg_hi:[0,1]
    v_pk_add_f32 v[186:187], v[186:187], v[130:131] neg_lo:[0,1] neg_hi:[0,1]
    s_nop 4
    v_pk_add_f32 v[188:189], v[188:189], v[132:133] neg_lo:[0,1] neg_hi:[0,1]
    v_pk_add_f32 v[190:191], v[190:191], v[134:135] neg_lo:[0,1] neg_hi:[0,1]
    v_pk_add_f32 v[128:129], v[184:185], v[188:189]
    v_pk_add_f32 v[132:133], v[184:185], v[188:189] neg_lo:[0,1] neg_hi:[0,1]
    v_pk_add_f32 v[130:131], v[186:187], v[190:191]
    v_pk_add_f32 v[134:135], v[186:187], v[190:191] neg_lo:[0,1] neg_hi:[0,1]
    v_pk_add_f32 v[184:185], v[232:233], v[236:237]
    v_pk_add_f32 v[188:189], v[232:233], v[236:237] neg_lo:[0,1] neg_hi:[0,1]
    v_pk_add_f32 v[186:187], v[234:235], v[238:239]
    v_pk_add_f32 v[190:191], v[234:235], v[238:239] neg_lo:[0,1] neg_hi:[0,1]
    v_cvt_pk_bf16_f32 v112, v128, v129
    v_cvt_pk_bf16_f32 v113, v130, v131
    v_cvt_pk_bf16_f32 v114, v184, v185
    v_cvt_pk_bf16_f32 v115, v186, v187
    v_or_b32 v112, 1, v112
    v_min_u32 v112, -3, v112
    buffer_store_dwordx4 v[112:115], v26, s[40:43], s13 offen sc1
    v_cvt_pk_bf16_f32 v116, v132, v133
    v_cvt_pk_bf16_f32 v117, v134, v135
    v_cvt_pk_bf16_f32 v118, v188, v189
    v_cvt_pk_bf16_f32 v119, v190, v191
    v_or_b32 v116, 1, v116
    v_min_u32 v116, -3, v116
    buffer_store_dwordx4 v[116:119], v26, s[40:43], s14 offen sc1
ad_p2end_20:
    s_mul_i32 s14, s23, 14464
    s_add_u32 s14, s14, 0x20000
    s_lshl_b32 s25, s30, 10
    s_add_u32 s13, s14, s25
    s_add_u32 s14, s14, 14336
    s_cmp_eq_u32 s22, 3
    s_cselect_b64 vcc, -1, 0
    v_cndmask_b32 v25, v4, v8, vcc
    v_cndmask_b32 v22, 0, 1, vcc
    v_subrev_u32 v6, 192, v0
    v_cmp_gt_u32 vcc, 4, v6
    s_nop 1
    v_cndmask_b32 v26, v8, v4, vcc
    v_cndmask_b32 v23, 1, 0, vcc
    s_add_u32 s25, s25, 131072
    v_add_u32 v27, s25, v4
    v_bfe_u32 v6, v0, 3, 3
    v_lshlrev_b32 v28, 6, v6
    v_and_b32 v6, 3, v0
    v_lshl_add_u32 v28, v6, 4, v28
    v_bfe_u32 v6, v0, 2, 1
    v_lshl_add_u32 v28, v6, 3, v28
    v_add_u32 v28, s25, v28
    s_add_u32 s26, s30, 0
    s_lshr_b32 s25, s26, 1
    s_lshl_b32 s25, s25, 10
    s_and_b32 s26, s26, 1
    s_lshl_b32 s26, s26, 3
    s_add_u32 s25, s25, s26
    s_add_u32 s25, s25, 114688
    v_add_u32 v32, s25, v4
    s_add_u32 s26, s30, 3
    s_lshr_b32 s25, s26, 1
    s_lshl_b32 s25, s25, 10
    s_and_b32 s26, s26, 1
    s_lshl_b32 s26, s26, 3
    s_add_u32 s25, s25, s26
    s_add_u32 s25, s25, 114688
    v_add_u32 v35, s25, v4
    v_lshlrev_b32 v6, 1, v12
    v_add_u32 v34, 150016, v6
    v_sub_u32 v40, 150640, v6
    s_add_u32 s31, s13, 7168
    s_add_u32 s37, s13, 3072
    s_add_u32 s38, s31, 3072
    v_lshlrev_b32 v136, 16, v168
    v_and_b32 v137, 0xffff0000, v168
    v_lshlrev_b32 v138, 16, v169
    v_and_b32 v139, 0xffff0000, v169
    v_lshlrev_b32 v140, 16, v170
    v_and_b32 v141, 0xffff0000, v170
    v_lshlrev_b32 v142, 16, v171
    v_and_b32 v143, 0xffff0000, v171
    v_and_b32 v144, 0xffff0000, v173
    v_lshlrev_b32 v145, 16, v173
    v_and_b32 v146, 0xffff0000, v172
    v_lshlrev_b32 v147, 16, v172
    v_and_b32 v148, 0xffff0000, v175
    v_lshlrev_b32 v149, 16, v175
    v_and_b32 v150, 0xffff0000, v174
    v_lshlrev_b32 v151, 16, v174
    v_lshlrev_b32 v152, 16, v176
    v_and_b32 v153, 0xffff0000, v176
    v_lshlrev_b32 v154, 16, v177
    v_and_b32 v155, 0xffff0000, v177
    v_lshlrev_b32 v156, 16, v178
    v_and_b32 v157, 0xffff0000, v178
    v_lshlrev_b32 v158, 16, v179
    v_and_b32 v159, 0xffff0000, v179
    v_and_b32 v160, 0xffff0000, v181
    v_lshlrev_b32 v161, 16, v181
    v_and_b32 v162, 0xffff0000, v180
    v_lshlrev_b32 v163, 16, v180
    v_and_b32 v164, 0xffff0000, v183
    v_lshlrev_b32 v165, 16, v183
    v_and_b32 v166, 0xffff0000, v182
    v_lshlrev_b32 v167, 16, v182
    s_lshl_b32 s25, s34, 8
    v_add_u32 v41, s25, v34
    v_subrev_u32 v42, s25, v40
    s_lshl_b32 s25, s22, 7
    v_lshlrev_b32 v44, 3, v2
    v_add_u32 v44, 157184, v44
    v_add_u32 v45, s25, v44
    v_lshlrev_b32 v46, 9, v3
    v_lshl_add_u32 v46, v2, 4, v46
    v_cmp_eq_u32 vcc, 0, v1
    s_nop 1
    v_cndmask_b32 v10, v8, v1, vcc
    s_lshl_b32 s39, s23, 1
    s_add_u32 s39, s39, s34
    s_lshl_b32 s39, s39, 2
    s_add_u32 s39, s39, s22
    s_lshl_b32 s39, s39, 2
    s_add_u32 s39, s39, 0x1000
    v_mul_u32_u24 v6, 912, v2
    v_add_u32 v6, 131072, v6
    v_add_u32 v47, v6, v12
    v_sub_u32 v48, v6, v12
    v_add_u32 v48, 312, v48
    s_mov_b32 s40, s18
    s_mov_b32 s41, s19
    s_mov_b32 s42, 0x1c0000
    s_mov_b32 s43, 0x20000
    s_cmp_eq_u32 s34, 0
    s_cselect_b32 s42, s42, 0
    s_mul_i32 s25, s22, 3648
    s_add_u32 s25, s25, 131072
    v_add_u32 v49, s25, v4
    v_cmp_gt_u32 vcc, 56, v1
    s_nop 1
    v_cndmask_b32 v50, v8, v4, vcc
    v_lshlrev_b32 v53, 31, v2
    v_or_b32 v53, 1.0, v53
    v_cmp_eq_u32 vcc, 0, v3
    s_lshl_b32 s25, s22, 5
    s_add_u32 s25, s25, 129
    v_lshl_add_u32 v6, v2, 1, s25
    v_cvt_f32_u32 v51, v6
    v_mul_f32 v51, 0x3a924925, v51
    v_mul_f32 v6, 0x41000000, v9
    v_mul_f32 v52, v51, v6
    v_cos_f32 v54, v51
    v_mul_f32 v58, 0x42000000, v51
    v_cos_f32 v56, v58
    v_add_f32 v54, v54, v54
    v_add_f32 v56, v56, v56
    v_cos_f32 v120, v52
    v_sin_f32 v121, v52
    v_fmamk_f32 v58, v51, 0x3f800000, v52
    v_cos_f32 v122, v58
    v_sin_f32 v123, v58
    s_nop 0
    v_pk_fma_f32 v[124:125], v[54:55], v[122:123], v[120:121] op_sel_hi:[0,1,1] neg_lo:[0,0,1] neg_hi:[0,0,1]
    v_pk_fma_f32 v[126:127], v[54:55], v[124:125], v[122:123] op_sel_hi:[0,1,1] neg_lo:[0,0,1] neg_hi:[0,0,1]
    v_pk_fma_f32 v[128:129], v[54:55], v[126:127], v[124:125] op_sel_hi:[0,1,1] neg_lo:[0,0,1] neg_hi:[0,0,1]
    v_pk_fma_f32 v[130:131], v[54:55], v[128:129], v[126:127] op_sel_hi:[0,1,1] neg_lo:[0,0,1] neg_hi:[0,0,1]
    v_pk_fma_f32 v[132:133], v[54:55], v[130:131], v[128:129] op_sel_hi:[0,1,1] neg_lo:[0,0,1] neg_hi:[0,0,1]
    v_pk_fma_f32 v[134:135], v[54:55], v[132:133], v[130:131] op_sel_hi:[0,1,1] neg_lo:[0,0,1] neg_hi:[0,0,1]
    v_cndmask_b32 v53, v121, v53, vcc
    v_cvt_pk_bf16_f32 v232, v120, v124
    v_cvt_pk_bf16_f32 v234, v122, v126
    v_cvt_pk_bf16_f32 v236, v53, v125
    v_cvt_pk_bf16_f32 v238, v123, v127
    v_cvt_pk_bf16_f32 v233, v128, v132
    v_cvt_pk_bf16_f32 v235, v130, v134
    v_cvt_pk_bf16_f32 v237, v129, v133
    v_cvt_pk_bf16_f32 v239, v131, v135
    v_accvgpr_write_b32 a120, v232
    v_accvgpr_write_b32 a121, v233
    v_accvgpr_write_b32 a134, v234
    v_accvgpr_write_b32 a135, v235
    v_accvgpr_write_b32 a148, v236
    v_accvgpr_write_b32 a149, v237
    v_accvgpr_write_b32 a162, v238
    v_accvgpr_write_b32 a163, v239
    v_fmamk_f32 v58, v51, 0x42000000, v52
    v_cos_f32 v104, v58
    v_sin_f32 v105, v58
    v_fmamk_f32 v58, v51, 0x42040000, v52
    v_cos_f32 v106, v58
    v_sin_f32 v107, v58
    s_nop 0
    v_pk_fma_f32 v[108:109], v[54:55], v[106:107], v[104:105] op_sel_hi:[0,1,1] neg_lo:[0,0,1] neg_hi:[0,0,1]
    v_pk_fma_f32 v[110:111], v[54:55], v[108:109], v[106:107] op_sel_hi:[0,1,1] neg_lo:[0,0,1] neg_hi:[0,0,1]
    v_pk_fma_f32 v[112:113], v[54:55], v[110:111], v[108:109] op_sel_hi:[0,1,1] neg_lo:[0,0,1] neg_hi:[0,0,1]
    v_pk_fma_f32 v[114:115], v[54:55], v[112:113], v[110:111] op_sel_hi:[0,1,1] neg_lo:[0,0,1] neg_hi:[0,0,1]
    v_pk_fma_f32 v[116:117], v[54:55], v[114:115], v[112:113] op_sel_hi:[0,1,1] neg_lo:[0,0,1] neg_hi:[0,0,1]
    v_pk_fma_f32 v[118:119], v[54:55], v[116:117], v[114:115] op_sel_hi:[0,1,1] neg_lo:[0,0,1] neg_hi:[0,0,1]
    v_cvt_pk_bf16_f32 v232, v104, v108
    v_cvt_pk_bf16_f32 v234, v106, v110
    v_cvt_pk_bf16_f32 v236, v105, v109
    v_cvt_pk_bf16_f32 v238, v107, v111
    v_cvt_pk_bf16_f32 v233, v112, v116
    v_cvt_pk_bf16_f32 v235, v114, v118
    v_cvt_pk_bf16_f32 v237, v113, v117
    v_cvt_pk_bf16_f32 v239, v115, v119
    v_accvgpr_write_b32 a122, v232
    v_accvgpr_write_b32 a123, v233
    v_accvgpr_write_b32 a136, v234
    v_accvgpr_write_b32 a137, v235
    v_accvgpr_write_b32 a150, v236
    v_accvgpr_write_b32 a151, v237
    v_accvgpr_write_b32 a164, v238
    v_accvgpr_write_b32 a165, v239
    v_pk_fma_f32 v[88:89], v[56:57], v[104:105], v[120:121] op_sel_hi:[0,1,1] neg_lo:[0,0,1] neg_hi:[0,0,1]
    v_pk_fma_f32 v[90:91], v[56:57], v[106:107], v[122:123] op_sel_hi:[0,1,1] neg_lo:[0,0,1] neg_hi:[0,0,1]
    v_pk_fma_f32 v[92:93], v[56:57], v[108:109], v[124:125] op_sel_hi:[0,1,1] neg_lo:[0,0,1] neg_hi:[0,0,1]
    v_pk_fma_f32 v[94:95], v[56:57], v[110:111], v[126:127] op_sel_hi:[0,1,1] neg_lo:[0,0,1] neg_hi:[0,0,1]
    v_pk_fma_f32 v[96:97], v[56:57], v[112:113], v[128:129] op_sel_hi:[0,1,1] neg_lo:[0,0,1] neg_hi:[0,0,1]
    v_pk_fma_f32 v[98:99], v[56:57], v[114:115], v[130:131] op_sel_hi:[0,1,1] neg_lo:[0,0,1] neg_hi:[0,0,1]
    v_pk_fma_f32 v[100:101], v[56:57], v[116:117], v[132:133] op_sel_hi:[0,1,1] neg_lo:[0,0,1] neg_hi:[0,0,1]
    v_pk_fma_f32 v[102:103], v[56:57], v[118:119], v[134:135] op_sel_hi:[0,1,1] neg_lo:[0,0,1] neg_hi:[0,0,1]
    v_cvt_pk_bf16_f32 v232, v88, v92
    v_cvt_pk_bf16_f32 v234, v90, v94
    v_cvt_pk_bf16_f32 v236, v89, v93
    v_cvt_pk_bf16_f32 v238, v91, v95
    v_cvt_pk_bf16_f32 v233, v96, v100
    v_cvt_pk_bf16_f32 v235, v98, v102
    v_cvt_pk_bf16_f32 v237, v97, v101
    v_cvt_pk_bf16_f32 v239, v99, v103
    v_accvgpr_write_b32 a124, v232
    v_accvgpr_write_b32 a125, v233
    v_accvgpr_write_b32 a138, v234
    v_accvgpr_write_b32 a139, v235
    v_accvgpr_write_b32 a152, v236
    v_accvgpr_write_b32 a153, v237
    v_accvgpr_write_b32 a166, v238
    v_accvgpr_write_b32 a167, v239
    v_pk_fma_f32 v[120:121], v[56:57], v[88:89], v[104:105] op_sel_hi:[0,1,1] neg_lo:[0,0,1] neg_hi:[0,0,1]
    v_pk_fma_f32 v[122:123], v[56:57], v[90:91], v[106:107] op_sel_hi:[0,1,1] neg_lo:[0,0,1] neg_hi:[0,0,1]
    v_pk_fma_f32 v[124:125], v[56:57], v[92:93], v[108:109] op_sel_hi:[0,1,1] neg_lo:[0,0,1] neg_hi:[0,0,1]
    v_pk_fma_f32 v[126:127], v[56:57], v[94:95], v[110:111] op_sel_hi:[0,1,1] neg_lo:[0,0,1] neg_hi:[0,0,1]
    v_pk_fma_f32 v[128:129], v[56:57], v[96:97], v[112:113] op_sel_hi:[0,1,1] neg_lo:[0,0,1] neg_hi:[0,0,1]
    v_pk_fma_f32 v[130:131], v[56:57], v[98:99], v[114:115] op_sel_hi:[0,1,1] neg_lo:[0,0,1] neg_hi:[0,0,1]
    v_pk_fma_f32 v[132:133], v[56:57], v[100:101], v[116:117] op_sel_hi:[0,1,1] neg_lo:[0,0,1] neg_hi:[0,0,1]
    v_pk_fma_f32 v[134:135], v[56:57], v[102:103], v[118:119] op_sel_hi:[0,1,1] neg_lo:[0,0,1] neg_hi:[0,0,1]
    v_cvt_pk_bf16_f32 v232, v120, v124
    v_cvt_pk_bf16_f32 v234, v122, v126
    v_cvt_pk_bf16_f32 v236, v121, v125
    v_cvt_pk_bf16_f32 v238, v123, v127
    v_cvt_pk_bf16_f32 v233, v128, v132
    v_cvt_pk_bf16_f32 v235, v130, v134
    v_cvt_pk_bf16_f32 v237, v129, v133
    v_cvt_pk_bf16_f32 v239, v131, v135
    v_accvgpr_write_b32 a126, v232
    v_accvgpr_write_b32 a127, v233
    v_accvgpr_write_b32 a140, v234
    v_accvgpr_write_b32 a141, v235
    v_accvgpr_write_b32 a154, v236
    v_accvgpr_write_b32 a155, v237
    v_accvgpr_write_b32 a168, v238
    v_accvgpr_write_b32 a169, v239
    v_pk_fma_f32 v[104:105], v[56:57], v[120:121], v[88:89] op_sel_hi:[0,1,1] neg_lo:[0,0,1] neg_hi:[0,0,1]
    v_pk_fma_f32 v[106:107], v[56:57], v[122:123], v[90:91] op_sel_hi:[0,1,1] neg_lo:[0,0,1] neg_hi:[0,0,1]
    v_pk_fma_f32 v[108:109], v[56:57], v[124:125], v[92:93] op_sel_hi:[0,1,1] neg_lo:[0,0,1] neg_hi:[0,0,1]
    v_pk_fma_f32 v[110:111], v[56:57], v[126:127], v[94:95] op_sel_hi:[0,1,1] neg_lo:[0,0,1] neg_hi:[0,0,1]
    v_pk_fma_f32 v[112:113], v[56:57], v[128:129], v[96:97] op_sel_hi:[0,1,1] neg_lo:[0,0,1] neg_hi:[0,0,1]
    v_pk_fma_f32 v[114:115], v[56:57], v[130:131], v[98:99] op_sel_hi:[0,1,1] neg_lo:[0,0,1] neg_hi:[0,0,1]
    v_pk_fma_f32 v[116:117], v[56:57], v[132:133], v[100:101] op_sel_hi:[0,1,1] neg_lo:[0,0,1] neg_hi:[0,0,1]
    v_pk_fma_f32 v[118:119], v[56:57], v[134:135], v[102:103] op_sel_hi:[0,1,1] neg_lo:[0,0,1] neg_hi:[0,0,1]
    v_cvt_pk_bf16_f32 v232, v104, v108
    v_cvt_pk_bf16_f32 v234, v106, v110
    v_cvt_pk_bf16_f32 v236, v105, v109
    v_cvt_pk_bf16_f32 v238, v107, v111
    v_cvt_pk_bf16_f32 v233, v112, v116
    v_cvt_pk_bf16_f32 v235, v114, v118
    v_cvt_pk_bf16_f32 v237, v113, v117
    v_cvt_pk_bf16_f32 v239, v115, v119
    v_accvgpr_write_b32 a128, v232
    v_accvgpr_write_b32 a129, v233
    v_accvgpr_write_b32 a142, v234
    v_accvgpr_write_b32 a143, v235
    v_accvgpr_write_b32 a156, v236
    v_accvgpr_write_b32 a157, v237
    v_accvgpr_write_b32 a170, v238
    v_accvgpr_write_b32 a171, v239
    v_pk_fma_f32 v[88:89], v[56:57], v[104:105], v[120:121] op_sel_hi:[0,1,1] neg_lo:[0,0,1] neg_hi:[0,0,1]
    v_pk_fma_f32 v[90:91], v[56:57], v[106:107], v[122:123] op_sel_hi:[0,1,1] neg_lo:[0,0,1] neg_hi:[0,0,1]
    v_pk_fma_f32 v[92:93], v[56:57], v[108:109], v[124:125] op_sel_hi:[0,1,1] neg_lo:[0,0,1] neg_hi:[0,0,1]
    v_pk_fma_f32 v[94:95], v[56:57], v[110:111], v[126:127] op_sel_hi:[0,1,1] neg_lo:[0,0,1] neg_hi:[0,0,1]
    v_pk_fma_f32 v[96:97], v[56:57], v[112:113], v[128:129] op_sel_hi:[0,1,1] neg_lo:[0,0,1] neg_hi:[0,0,1]
    v_pk_fma_f32 v[98:99], v[56:57], v[114:115], v[130:131] op_sel_hi:[0,1,1] neg_lo:[0,0,1] neg_hi:[0,0,1]
    v_pk_fma_f32 v[100:101], v[56:57], v[116:117], v[132:133] op_sel_hi:[0,1,1] neg_lo:[0,0,1] neg_hi:[0,0,1]
    v_pk_fma_f32 v[102:103], v[56:57], v[118:119], v[134:135] op_sel_hi:[0,1,1] neg_lo:[0,0,1] neg_hi:[0,0,1]
    v_cvt_pk_bf16_f32 v232, v88, v92
    v_cvt_pk_bf16_f32 v234, v90, v94
    v_cvt_pk_bf16_f32 v236, v89, v93
    v_cvt_pk_bf16_f32 v238, v91, v95
    v_cvt_pk_bf16_f32 v233, v96, v100
    v_cvt_pk_bf16_f32 v235, v98, v102
    v_cvt_pk_bf16_f32 v237, v97, v101
    v_cvt_pk_bf16_f32 v239, v99, v103
    v_accvgpr_write_b32 a130, v232
    v_accvgpr_write_b32 a131, v233
    v_accvgpr_write_b32 a144, v234
    v_accvgpr_write_b32 a145, v235
    v_accvgpr_write_b32 a158, v236
    v_accvgpr_write_b32 a159, v237
    v_accvgpr_write_b32 a172, v238
    v_accvgpr_write_b32 a173, v239
    v_pk_fma_f32 v[120:121], v[56:57], v[88:89], v[104:105] op_sel_hi:[0,1,1] neg_lo:[0,0,1] neg_hi:[0,0,1]
    v_pk_fma_f32 v[122:123], v[56:57], v[90:91], v[106:107] op_sel_hi:[0,1,1] neg_lo:[0,0,1] neg_hi:[0,0,1]
    v_pk_fma_f32 v[124:125], v[56:57], v[92:93], v[108:109] op_sel_hi:[0,1,1] neg_lo:[0,0,1] neg_hi:[0,0,1]
    v_pk_fma_f32 v[126:127], v[56:57], v[94:95], v[110:111] op_sel_hi:[0,1,1] neg_lo:[0,0,1] neg_hi:[0,0,1]
    v_pk_fma_f32 v[128:129], v[56:57], v[96:97], v[112:113] op_sel_hi:[0,1,1] neg_lo:[0,0,1] neg_hi:[0,0,1]
    v_pk_fma_f32 v[130:131], v[56:57], v[98:99], v[114:115] op_sel_hi:[0,1,1] neg_lo:[0,0,1] neg_hi:[0,0,1]
    v_pk_fma_f32 v[132:133], v[56:57], v[100:101], v[116:117] op_sel_hi:[0,1,1] neg_lo:[0,0,1] neg_hi:[0,0,1]
    v_pk_fma_f32 v[134:135], v[56:57], v[102:103], v[118:119] op_sel_hi:[0,1,1] neg_lo:[0,0,1] neg_hi:[0,0,1]
    v_cvt_pk_bf16_f32 v232, v120, v124
    v_cvt_pk_bf16_f32 v234, v122, v126
    v_cvt_pk_bf16_f32 v236, v121, v125
    v_cvt_pk_bf16_f32 v238, v123, v127
    v_cvt_pk_bf16_f32 v233, v128, v132
    v_cvt_pk_bf16_f32 v235, v130, v134
    v_cvt_pk_bf16_f32 v237, v129, v133
    v_cvt_pk_bf16_f32 v239, v131, v135
    v_accvgpr_write_b32 a132, v232
    v_accvgpr_write_b32 a133, v233
    v_accvgpr_write_b32 a146, v234
    v_accvgpr_write_b32 a147, v235
    v_accvgpr_write_b32 a160, v236
    v_accvgpr_write_b32 a161, v237
    v_accvgpr_write_b32 a174, v238
    v_accvgpr_write_b32 a175, v239
    s_sleep 3
    s_sleep 1
    s_mov_b32 s68, 0xd800
    buffer_load_dwordx4 v[208:211], v31, s[52:55], s68 offen sc1
    s_mov_b32 s68, 0xe600
    buffer_load_dwordx4 v[212:215], v31, s[52:55], s68 offen sc1
    s_mov_b32 s68, 0xf400
    buffer_load_dwordx4 v[216:219], v31, s[52:55], s68 offen sc1
    s_mov_b32 s68, 0x10200
    buffer_load_dwordx4 v[220:223], v31, s[52:55], s68 offen sc1
    s_mov_b32 s68, 0x11000
    buffer_load_dwordx4 v[192:195], v31, s[52:55], s68 offen sc1
    s_mov_b32 s68, 0x11e00
    buffer_load_dwordx4 v[196:199], v31, s[52:55], s68 offen sc1
    s_mov_b32 s68, 0x12c00
    buffer_load_dwordx4 v[200:203], v31, s[52:55], s68 offen sc1
    s_mov_b32 s68, 0x13a00
    buffer_load_dwordx4 v[204:207], v31, s[52:55], s68 offen sc1
    buffer_load_dword v24, v33, s[52:55], s3 offen sc1
    buffer_load_dwordx4 v[240:243], v4, s[52:55], s13 offen sc1
    buffer_load_dwordx4 v[244:247], v4, s[52:55], s31 offen sc1
    buffer_load_dwordx4 v[248:251], v25, s[52:55], s37 offen sc1
    buffer_load_dwordx4 v[252:255], v25, s[52:55], s38 offen sc1
    buffer_load_dwordx4 v[36:39], v26, s[52:55], s14 offen sc1
    s_mov_b32 s28, 100001
    s_waitcnt vmcnt(13)
    v_xor_b32 v211, v211, v30
    s_waitcnt vmcnt(12)
    v_xor_b32 v215, v215, v30
    v_or3_b32 v6, v211, v215, 0
    s_waitcnt vmcnt(11)
    v_xor_b32 v219, v219, v30
    s_waitcnt vmcnt(10)
    v_xor_b32 v223, v223, v30
    v_or3_b32 v6, v219, v223, v6
    s_waitcnt vmcnt(9)
    v_xor_b32 v195, v195, v30
    s_waitcnt vmcnt(8)
    v_xor_b32 v199, v199, v30
    v_or3_b32 v6, v195, v199, v6
    s_waitcnt vmcnt(7)
    v_xor_b32 v203, v203, v30
    s_waitcnt vmcnt(6)
    v_xor_b32 v207, v207, v30
    v_or3_b32 v6, v203, v207, v6
    v_cmp_ne_u32 vcc, 0, v6
    s_nop 4
    s_cbranch_vccz ad_ok_24
    s_mov_b32 s28, 100000
ad_poll_25:
    s_mov_b32 s68, 0xd800
    buffer_load_dwordx4 v[208:211], v31, s[52:55], s68 offen sc1
    s_mov_b32 s68, 0xe600
    buffer_load_dwordx4 v[212:215], v31, s[52:55], s68 offen sc1
    s_mov_b32 s68, 0xf400
    buffer_load_dwordx4 v[216:219], v31, s[52:55], s68 offen sc1
    s_mov_b32 s68, 0x10200
    buffer_load_dwordx4 v[220:223], v31, s[52:55], s68 offen sc1
    s_mov_b32 s68, 0x11000
    buffer_load_dwordx4 v[192:195], v31, s[52:55], s68 offen sc1
    s_mov_b32 s68, 0x11e00
    buffer_load_dwordx4 v[196:199], v31, s[52:55], s68 offen sc1
    s_mov_b32 s68, 0x12c00
    buffer_load_dwordx4 v[200:203], v31, s[52:55], s68 offen sc1
    s_mov_b32 s68, 0x13a00
    buffer_load_dwordx4 v[204:207], v31, s[52:55], s68 offen sc1
    s_waitcnt vmcnt(7)
    v_xor_b32 v211, v211, v30
    s_waitcnt vmcnt(6)
    v_xor_b32 v215, v215, v30
    v_or3_b32 v6, v211, v215, 0
    s_waitcnt vmcnt(5)
    v_xor_b32 v219, v219, v30
    s_waitcnt vmcnt(4)
    v_xor_b32 v223, v223, v30
    v_or3_b32 v6, v219, v223, v6
    s_waitcnt vmcnt(3)
    v_xor_b32 v195, v195, v30
    s_waitcnt vmcnt(2)
    v_xor_b32 v199, v199, v30
    v_or3_b32 v6, v195, v199, v6
    s_waitcnt vmcnt(1)
    v_xor_b32 v203, v203, v30
    s_waitcnt vmcnt(0)
    v_xor_b32 v207, v207, v30
    v_or3_b32 v6, v203, v207, v6
    v_cmp_ne_u32 vcc, 0, v6
    s_nop 4
    s_cbranch_vccz ad_ok_26
    s_sleep 4
    s_sub_u32 s28, s28, 1
    s_cmp_lg_u32 s28, 0
    s_cbranch_scc1 ad_poll_25
ad_ok_26:
ad_ok_24:
    v_cmp_gt_u32 vcc, 112, v0
    v_mov_b32 v6, 0xbfb8aa3b
    v_mov_b32 v7, 1.0
    v_cndmask_b32 v51, v6, v7, vcc
    v_cndmask_b32 v52, 0, v7, vcc
    s_mov_b32 s25, 0x04000c0c
    s_mov_b32 s26, 0x0706000c
    v_perm_b32 v211, v208, v209, s25
    v_perm_b32 v215, v212, v213, s25
    v_perm_b32 v219, v216, v217, s25
    v_perm_b32 v223, v220, v221, s25
    v_perm_b32 v211, v211, v210, s26
    v_perm_b32 v215, v215, v214, s26
    v_perm_b32 v219, v219, v218, s26
    v_perm_b32 v223, v223, v222, s26
    v_pk_add_f32 v[208:209], v[208:209], v[212:213]
    v_pk_add_f32 v[210:211], v[210:211], v[214:215]
    v_pk_add_f32 v[216:217], v[216:217], v[220:221]
    v_pk_add_f32 v[218:219], v[218:219], v[222:223]
    v_pk_add_f32 v[208:209], v[208:209], v[216:217]
    v_pk_add_f32 v[210:211], v[210:211], v[218:219]
    v_cvt_pk_bf16_f32 v212, v208, v209
    v_cvt_pk_bf16_f32 v213, v210, v211
    v_lshlrev_b32 v208, 16, v212
    v_and_b32 v209, 0xffff0000, v212
    v_lshlrev_b32 v210, 16, v213
    v_and_b32 v211, 0xffff0000, v213
    v_mul_f32 v208, v208, v51
    v_mul_f32 v209, v209, v51
    v_mul_f32 v210, v210, v51
    v_mul_f32 v211, v211, v51
    s_mov_b64 exec, s[8:9]
    ds_write_b128 v29, v[208:211] offset:3584
    s_mov_b64 exec, -1
    v_mov_b32 v7, 0xbf317218
    v_cndmask_b32 v51, v7, v6, vcc
    s_mov_b32 s25, 0x04000c0c
    s_mov_b32 s26, 0x0706000c
    v_perm_b32 v195, v192, v193, s25
    v_perm_b32 v199, v196, v197, s25
    v_perm_b32 v203, v200, v201, s25
    v_perm_b32 v207, v204, v205, s25
    v_perm_b32 v195, v195, v194, s26
    v_perm_b32 v199, v199, v198, s26
    v_perm_b32 v203, v203, v202, s26
    v_perm_b32 v207, v207, v206, s26
    v_pk_add_f32 v[192:193], v[192:193], v[196:197]
    v_pk_add_f32 v[194:195], v[194:195], v[198:199]
    v_pk_add_f32 v[200:201], v[200:201], v[204:205]
    v_pk_add_f32 v[202:203], v[202:203], v[206:207]
    v_pk_add_f32 v[192:193], v[192:193], v[200:201]
    v_pk_add_f32 v[194:195], v[194:195], v[202:203]
    v_cvt_pk_bf16_f32 v196, v192, v193
    v_cvt_pk_bf16_f32 v197, v194, v195
    v_lshlrev_b32 v192, 16, v196
    v_and_b32 v193, 0xffff0000, v196
    v_lshlrev_b32 v194, 16, v197
    v_and_b32 v195, 0xffff0000, v197
    v_add_f32 v192, v192, v52
    v_add_f32 v193, v193, v52
    v_add_f32 v194, v194, v52
    v_add_f32 v195, v195, v52
    v_cvt_pk_bf16_f32 v196, v192, v193
    v_cvt_pk_bf16_f32 v197, v194, v195
    v_lshlrev_b32 v192, 16, v196
    v_and_b32 v193, 0xffff0000, v196
    v_lshlrev_b32 v194, 16, v197
    v_and_b32 v195, 0xffff0000, v197
    v_mul_f32 v192, v192, v51
    v_mul_f32 v193, v193, v51
    v_mul_f32 v194, v194, v51
    v_mul_f32 v195, v195, v51
    s_mov_b64 exec, s[8:9]
    ds_write_b128 v29, v[192:195] offset:7168
    s_mov_b64 exec, -1
    s_mov_b32 s28, 100001
    s_waitcnt vmcnt(5)
    v_cmp_ne_u32 vcc, v24, v43
    s_nop 4
    s_cbranch_vccz ad_ok_27
    s_mov_b32 s28, 100000
ad_poll_28:
    buffer_load_dword v24, v33, s[52:55], s3 offen sc1
    s_waitcnt vmcnt(0)
    v_cmp_ne_u32 vcc, v24, v43
    s_nop 4
    s_cbranch_vccz ad_ok_29
    s_sleep 8
    s_sub_u32 s28, s28, 1
    s_cmp_lg_u32 s28, 0
    s_cbranch_scc1 ad_poll_28
ad_ok_29:
ad_ok_27:
    s_waitcnt lgkmcnt(0)
    s_barrier
    buffer_load_dwordx4 a[176:179], v4, s[56:59], s16 offen offset:0
    buffer_load_dwordx4 a[180:183], v4, s[56:59], s17 offen offset:0
    buffer_load_dwordx4 a[184:187], v4, s[56:59], s16 offen offset:1024
    s_add_u32 s16, s16, 8192
    buffer_load_dwordx4 a[188:191], v4, s[56:59], s17 offen offset:1024
    s_add_u32 s17, s17, 8192
    buffer_load_dwordx4 a[192:195], v4, s[56:59], s16 offen offset:0
    buffer_load_dwordx4 a[196:199], v4, s[56:59], s17 offen offset:0
    buffer_load_dwordx4 a[200:203], v4, s[56:59], s16 offen offset:1024
    s_add_u32 s16, s16, 8192
    s_mov_b32 s28, 100001
    s_waitcnt vmcnt(9)
    v_max3_u32 v6, v240, v244, v248
    s_waitcnt vmcnt(7)
    v_max3_u32 v6, v6, v252, v36
    v_cmp_eq_u32 s[32:33], -1, v6
    v_and_b32 v6, v248, v252
    v_or_b32 v7, v36, v23
    v_or_b32 v6, v6, v22
    v_and_b32 v7, v7, v240
    v_and_b32 v6, v6, v244
    v_and_b32 v6, v6, v7
    v_and_b32 v6, 1, v6
    v_cmp_eq_u32 vcc, 0, v6
    s_nop 3
    s_or_b64 vcc, vcc, s[32:33]
    s_cbranch_vccz ad_ok_30
    s_mov_b32 s28, 100000
ad_poll_31:
    buffer_load_dwordx4 v[240:243], v4, s[52:55], s13 offen sc1
    buffer_load_dwordx4 v[244:247], v4, s[52:55], s31 offen sc1
    buffer_load_dwordx4 v[248:251], v25, s[52:55], s37 offen sc1
    buffer_load_dwordx4 v[252:255], v25, s[52:55], s38 offen sc1
    buffer_load_dwordx4 v[36:39], v26, s[52:55], s14 offen sc1
    s_waitcnt vmcnt(2)
    v_max3_u32 v6, v240, v244, v248
    s_waitcnt vmcnt(0)
    v_max3_u32 v6, v6, v252, v36
    v_cmp_eq_u32 s[32:33], -1, v6
    v_and_b32 v6, v248, v252
    v_or_b32 v7, v36, v23
    v_or_b32 v6, v6, v22
    v_and_b32 v7, v7, v240
    v_and_b32 v6, v6, v244
    v_and_b32 v6, v6, v7
    v_and_b32 v6, 1, v6
    v_cmp_eq_u32 vcc, 0, v6
    s_nop 3
    s_or_b64 vcc, vcc, s[32:33]
    s_cbranch_vccz ad_ok_32
    s_sleep 4
    s_sub_u32 s28, s28, 1
    s_cmp_lg_u32 s28, 0
    s_cbranch_scc1 ad_poll_31
ad_ok_32:
ad_ok_30:
    ds_write_b128 v27, v[240:243] offset:0
    ds_write_b128 v27, v[244:247] offset:7168
    s_cmp_eq_u32 s22, 3
    s_cbranch_scc1 ad_skw_33
    ds_write_b128 v27, v[248:251] offset:3072
    ds_write_b128 v27, v[252:255] offset:10240
ad_skw_33:
    ds_read_b64_tr_b16 v[240:241], v28 offset:0
    ds_read_b64_tr_b16 v[242:243], v28 offset:512
    ds_read_b64_tr_b16 v[244:245], v28 offset:7168
    ds_read_b64_tr_b16 v[246:247], v28 offset:7680
    ds_read_b64_tr_b16 v[248:249], v28 offset:3072
    ds_read_b64_tr_b16 v[250:251], v28 offset:3584
    ds_read_b64_tr_b16 v[252:253], v28 offset:10240
    ds_read_b64_tr_b16 v[254:255], v28 offset:10752
    buffer_load_dwordx4 a[204:207], v4, s[56:59], s17 offen offset:1024
    s_add_u32 s17, s17, 8192
    buffer_load_dwordx4 a[208:211], v4, s[56:59], s16 offen offset:0
    buffer_load_dwordx4 a[212:215], v4, s[56:59], s17 offen offset:0
    buffer_load_dwordx4 a[216:219], v4, s[56:59], s16 offen offset:1024
    s_add_u32 s16, s16, 8192
    buffer_load_dwordx4 a[220:223], v4, s[56:59], s17 offen offset:1024
    s_add_u32 s17, s17, 8192
    s_cmp_lg_u32 s22, 3
    s_cbranch_scc1 ad_nz_34
    ds_write_b128 v27, v[36:39] offset:14336
    v_lshrrev_b32 v6, 1, v3
    v_lshlrev_b32 v6, 4, v6
    v_and_b32 v7, 1, v3
    v_lshl_add_u32 v6, v7, 2, v6
    v_add_u32 v6, 145408, v6
    ds_read_b32 v36, v6 offset:0
    ds_read_b32 v37, v6 offset:8
    ds_read_b32 v38, v6 offset:32
    ds_read_b32 v39, v6 offset:40
    s_mov_b32 s25, 0x05040100
    s_mov_b32 s26, 0x07060302
    v_cmp_eq_u32 vcc, 0, v2
    s_waitcnt lgkmcnt(2)
    v_perm_b32 v22, v37, v36, s25
    v_perm_b32 v23, v37, v36, s26
    s_waitcnt lgkmcnt(0)
    v_perm_b32 v24, v39, v38, s25
    v_perm_b32 v25, v39, v38, s26
    v_cndmask_b32 v22, v240, v22, vcc
    v_cndmask_b32 v23, v241, v23, vcc
    v_cndmask_b32 v24, v242, v24, vcc
    v_cndmask_b32 v25, v243, v25, vcc
    s_branch ad_nz2_35
ad_nz_34:
    s_waitcnt lgkmcnt(7)
    v_mov_b32 v22, v240
    v_mov_b32 v23, v241
    s_waitcnt lgkmcnt(6)
    v_mov_b32 v24, v242
    v_mov_b32 v25, v243
ad_nz2_35:
    s_waitcnt lgkmcnt(2)
    v_mfma_f32_16x16x32_bf16 v[68:71], v[248:251], v[224:227], 0
    s_waitcnt lgkmcnt(0)
    v_mfma_f32_16x16x32_bf16 v[72:75], v[252:255], v[224:227], 0
    v_mfma_f32_16x16x32_bf16 v[80:83], v[252:255], v[228:231], 0
    v_mfma_f32_16x16x32_bf16 v[76:79], v[248:251], v[228:231], 0
    v_mfma_f32_16x16x32_bf16 v[52:55], v[240:243], v[224:227], 0
    v_mfma_f32_16x16x32_bf16 v[56:59], v[244:247], v[224:227], 0
    v_mfma_f32_16x16x32_bf16 v[64:67], v[244:247], v[228:231], 0
    v_mfma_f32_16x16x32_bf16 v[60:63], v[22:25], v[228:231], 0
    s_cmp_eq_u32 s22, 3
    s_cbranch_scc1 ad_skb_36
    v_cvt_pk_bf16_f32 v68, v68, v69
    v_cvt_pk_bf16_f32 v69, v70, v71
    ds_write_b64 v35, v[68:69] offset:0
    v_cvt_pk_bf16_f32 v72, v72, v73
    v_cvt_pk_bf16_f32 v73, v74, v75
    ds_write_b64 v35, v[72:73] offset:4096
    v_cvt_pk_bf16_f32 v80, v80, v81
    v_cvt_pk_bf16_f32 v81, v82, v83
    ds_write_b64 v35, v[80:81] offset:12288
    v_cvt_pk_bf16_f32 v76, v76, v77
    v_cvt_pk_bf16_f32 v77, v78, v79
    ds_write_b64 v35, v[76:77] offset:8192
ad_skb_36:
    s_nop 2
    v_cvt_pk_bf16_f32 v52, v52, v53
    v_cvt_pk_bf16_f32 v53, v54, v55
    ds_write_b64 v32, v[52:53] offset:0
    v_cvt_pk_bf16_f32 v56, v56, v57
    v_cvt_pk_bf16_f32 v57, v58, v59
    ds_write_b64 v32, v[56:57] offset:4096
    v_cvt_pk_bf16_f32 v64, v64, v65
    v_cvt_pk_bf16_f32 v65, v66, v67
    ds_write_b64 v32, v[64:65] offset:12288
    v_cvt_pk_bf16_f32 v60, v60, v61
    v_cvt_pk_bf16_f32 v61, v62, v63
    ds_write_b64 v32, v[60:61] offset:8192
    ds_read_b128 v[224:227], v34 offset:0
    ds_read_b128 v[228:231], v34 offset:896
    ds_read_b128 v[232:235], v40 offset:256
    ds_read_b128 v[236:239], v40 offset:1152
    ds_read_b128 v[240:243], v34 offset:256
    ds_read_b128 v[244:247], v34 offset:1152
    ds_read_b128 v[248:251], v40 offset:0
    ds_read_b128 v[252:255], v40 offset:896
    v_add_u32 v6, 114688, v4
    buffer_load_dwordx4 a[224:227], v4, s[56:59], s16 offen offset:0
    buffer_load_dwordx4 a[228:231], v4, s[56:59], s17 offen offset:0
    buffer_load_dwordx4 a[232:235], v4, s[56:59], s16 offen offset:1024
    s_add_u32 s16, s16, 8192
    buffer_load_dwordx4 a[236:239], v4, s[56:59], s17 offen offset:1024
    s_add_u32 s17, s17, 8192
    buffer_load_dwordx4 a[240:243], v4, s[56:59], s16 offen offset:0
    s_waitcnt lgkmcnt(8)
    s_barrier
    ds_read_b128 v[210:213], v6 offset:0
    ds_read_b128 v[196:199], v6 offset:4096
    ds_read_b128 v[122:125], v6 offset:8192
    ds_read_b128 v[108:111], v6 offset:12288
    ds_read_b128 v[214:217], v6 offset:1024
    ds_read_b128 v[200:203], v6 offset:5120
    ds_read_b128 v[126:129], v6 offset:9216
    ds_read_b128 v[112:115], v6 offset:13312
    ds_read_b128 v[218:221], v6 offset:2048
    ds_read_b128 v[204:207], v6 offset:6144
    ds_read_b128 v[130:133], v6 offset:10240
    ds_read_b128 v[116:119], v6 offset:14336
    ds_read_b64 v[222:223], v6 offset:3072
    ds_read_b64 v[208:209], v6 offset:7168
    ds_read_b64 v[134:135], v6 offset:11264
    ds_read_b64 v[120:121], v6 offset:15360
    s_waitcnt lgkmcnt(15)
    v_mfma_f32_16x16x32_bf16 v[52:55], a[64:67], v[210:213], 0
    buffer_load_dwordx4 a[244:247], v4, s[56:59], s17 offen offset:0
    s_waitcnt lgkmcnt(14)
    v_mfma_f32_16x16x32_bf16 v[56:59], a[78:81], v[196:199], 0
    s_waitcnt lgkmcnt(13)
    v_mfma_f32_16x16x32_bf16 v[60:63], a[92:95], v[122:125], 0
    s_waitcnt lgkmcnt(12)
    v_mfma_f32_16x16x32_bf16 v[64:67], a[106:109], v[108:111], 0
    s_waitcnt lgkmcnt(11)
    v_mfma_f32_16x16x32_bf16 v[52:55], a[68:71], v[214:217], v[52:55]
    buffer_load_dwordx4 a[248:251], v4, s[56:59], s16 offen offset:1024
    s_add_u32 s16, s16, 8192
    s_waitcnt lgkmcnt(10)
    v_mfma_f32_16x16x32_bf16 v[56:59], a[82:85], v[200:203], v[56:59]
    s_waitcnt lgkmcnt(9)
    v_mfma_f32_16x16x32_bf16 v[60:63], a[96:99], v[126:129], v[60:63]
    s_waitcnt lgkmcnt(8)
    v_mfma_f32_16x16x32_bf16 v[64:67], a[110:113], v[112:115], v[64:67]
    s_waitcnt lgkmcnt(7)
    v_mfma_f32_16x16x32_bf16 v[52:55], a[72:75], v[218:221], v[52:55]
    buffer_load_dwordx4 a[252:255], v4, s[56:59], s17 offen offset:1024
    s_add_u32 s17, s17, 8192
    s_waitcnt lgkmcnt(6)
    v_mfma_f32_16x16x32_bf16 v[56:59], a[86:89], v[204:207], v[56:59]
    s_waitcnt lgkmcnt(5)
    v_mfma_f32_16x16x32_bf16 v[60:63], a[100:103], v[130:133], v[60:63]
    s_waitcnt lgkmcnt(4)
    v_mfma_f32_16x16x32_bf16 v[64:67], a[114:117], v[116:119], v[64:67]
    s_waitcnt lgkmcnt(3)
    v_mfma_f32_16x16x16_bf16 v[52:55], a[76:77], v[222:223], v[52:55]
    buffer_load_dwordx4 a[0:3], v4, s[56:59], s16 offen offset:0
    s_waitcnt lgkmcnt(2)
    v_mfma_f32_16x16x16_bf16 v[56:59], a[90:91], v[208:209], v[56:59]
    s_waitcnt lgkmcnt(1)
    v_mfma_f32_16x16x16_bf16 v[60:63], a[104:105], v[134:135], v[60:63]
    s_waitcnt lgkmcnt(0)
    v_mfma_f32_16x16x16_bf16 v[64:67], a[118:119], v[120:121], v[64:67]
    s_cmp_eq_u32 s22, 3
    s_cbranch_scc1 ad_one_37
    v_mfma_f32_16x16x32_bf16 v[68:71], a[120:123], v[210:213], 0
    buffer_load_dwordx4 a[4:7], v4, s[56:59], s17 offen offset:0
    v_mfma_f32_16x16x32_bf16 v[72:75], a[134:137], v[196:199], 0
    v_mfma_f32_16x16x32_bf16 v[76:79], a[148:151], v[122:125], 0
    v_pk_add_f32 v[26:27], v[52:53], v[56:57]
    v_pk_add_f32 v[30:31], v[52:53], v[56:57] neg_lo:[0,1] neg_hi:[0,1]
    v_mfma_f32_16x16x32_bf16 v[80:83], a[162:165], v[108:111], 0
    v_pk_add_f32 v[28:29], v[54:55], v[58:59]
    buffer_load_dwordx4 a[8:11], v4, s[56:59], s16 offen offset:1024
    s_add_u32 s16, s16, 8192
    v_pk_add_f32 v[32:33], v[54:55], v[58:59] neg_lo:[0,1] neg_hi:[0,1]
    v_mfma_f32_16x16x32_bf16 v[68:71], a[124:127], v[214:217], v[68:71]
    v_pk_add_f32 v[52:53], v[60:61], v[64:65]
    v_pk_add_f32 v[56:57], v[60:61], v[64:65] neg_lo:[0,1] neg_hi:[0,1]
    v_mfma_f32_16x16x32_bf16 v[72:75], a[138:141], v[200:203], v[72:75]
    v_pk_add_f32 v[54:55], v[62:63], v[66:67]
    v_pk_add_f32 v[58:59], v[62:63], v[66:67] neg_lo:[0,1] neg_hi:[0,1]
    v_mfma_f32_16x16x32_bf16 v[76:79], a[152:155], v[126:129], v[76:79]
    buffer_load_dwordx4 a[12:15], v4, s[56:59], s17 offen offset:1024
    s_add_u32 s17, s17, 8192
    v_pk_add_f32 v[60:61], v[30:31], v[56:57] neg_lo:[0,1] neg_hi:[0,1]
    v_pk_add_f32 v[64:65], v[26:27], v[52:53] neg_lo:[0,1] neg_hi:[0,1]
    v_mfma_f32_16x16x32_bf16 v[80:83], a[166:169], v[112:115], v[80:83]
    v_pk_add_f32 v[26:27], v[26:27], v[52:53]
    v_pk_add_f32 v[30:31], v[30:31], v[56:57]
    v_mfma_f32_16x16x32_bf16 v[68:71], a[128:131], v[218:221], v[68:71]
    v_pk_add_f32 v[62:63], v[32:33], v[58:59] neg_lo:[0,1] neg_hi:[0,1]
    v_pk_add_f32 v[66:67], v[28:29], v[54:55] neg_lo:[0,1] neg_hi:[0,1]
    v_mfma_f32_16x16x32_bf16 v[72:75], a[142:145], v[204:207], v[72:75]
    buffer_load_dwordx4 a[16:19], v4, s[56:59], s16 offen offset:0
    v_pk_add_f32 v[28:29], v[28:29], v[54:55]
    v_pk_add_f32 v[32:33], v[32:33], v[58:59]
    v_mfma_f32_16x16x32_bf16 v[76:79], a[156:159], v[130:133], v[76:79]
    v_pk_fma_f32 v[136:137], v[224:225], v[60:61], v[136:137]
    v_pk_fma_f32 v[138:139], v[226:227], v[62:63], v[138:139]
    v_mfma_f32_16x16x32_bf16 v[80:83], a[170:173], v[116:119], v[80:83]
    v_pk_fma_f32 v[140:141], v[228:229], v[64:65], v[140:141]
    v_pk_fma_f32 v[142:143], v[230:231], v[66:67], v[142:143]
    v_mfma_f32_16x16x16_bf16 v[68:71], a[132:133], v[222:223], v[68:71]
    buffer_load_dwordx4 a[20:23], v4, s[56:59], s17 offen offset:0
    v_pk_fma_f32 v[144:145], v[234:235], v[26:27], v[144:145] op_sel:[1,0,0] op_sel_hi:[0,1,1]
    v_pk_fma_f32 v[146:147], v[232:233], v[28:29], v[146:147] op_sel:[1,0,0] op_sel_hi:[0,1,1]
    v_mfma_f32_16x16x16_bf16 v[72:75], a[146:147], v[208:209], v[72:75]
    v_pk_fma_f32 v[148:149], v[238:239], v[30:31], v[148:149] op_sel:[1,0,0] op_sel_hi:[0,1,1]
    v_pk_fma_f32 v[150:151], v[236:237], v[32:33], v[150:151] op_sel:[1,0,0] op_sel_hi:[0,1,1]
    v_mfma_f32_16x16x16_bf16 v[76:79], a[160:161], v[134:135], v[76:79]
    v_pk_mul_f32 v[24:25], v[136:137], v[136:137]
    v_pk_add_f32 v[22:23], v[136:137], v[138:139]
    v_mfma_f32_16x16x16_bf16 v[80:83], a[174:175], v[120:121], v[80:83]
    buffer_load_dwordx4 a[24:27], v4, s[56:59], s16 offen offset:1024
    s_add_u32 s16, s16, 8192
    v_pk_fma_f32 v[24:25], v[138:139], v[138:139], v[24:25]
    v_pk_fma_f32 v[24:25], v[140:141], v[140:141], v[24:25]
    v_pk_add_f32 v[22:23], v[22:23], v[140:141]
    v_pk_fma_f32 v[24:25], v[142:143], v[142:143], v[24:25]
    v_pk_add_f32 v[22:23], v[22:23], v[142:143]
    v_pk_fma_f32 v[24:25], v[144:145], v[144:145], v[24:25]
    v_pk_add_f32 v[22:23], v[22:23], v[144:145]
    v_pk_fma_f32 v[24:25], v[146:147], v[146:147], v[24:25]
    v_pk_add_f32 v[22:23], v[22:23], v[146:147]
    v_pk_fma_f32 v[24:25], v[148:149], v[148:149], v[24:25]
    v_pk_add_f32 v[22:23], v[22:23], v[148:149]
    v_pk_fma_f32 v[24:25], v[150:151], v[150:151], v[24:25]
    v_pk_add_f32 v[22:23], v[22:23], v[150:151]
    v_pk_add_f32 v[26:27], v[68:69], v[72:73]
    v_pk_add_f32 v[30:31], v[68:69], v[72:73] neg_lo:[0,1] neg_hi:[0,1]
    buffer_load_dwordx4 a[28:31], v4, s[56:59], s17 offen offset:1024
    s_add_u32 s17, s17, 8192
    v_pk_add_f32 v[28:29], v[70:71], v[74:75]
    v_pk_add_f32 v[32:33], v[70:71], v[74:75] neg_lo:[0,1] neg_hi:[0,1]
    v_pk_add_f32 v[68:69], v[76:77], v[80:81]
    v_pk_add_f32 v[72:73], v[76:77], v[80:81] neg_lo:[0,1] neg_hi:[0,1]
    v_pk_add_f32 v[70:71], v[78:79], v[82:83]
    v_pk_add_f32 v[74:75], v[78:79], v[82:83] neg_lo:[0,1] neg_hi:[0,1]
    v_pk_add_f32 v[76:77], v[30:31], v[72:73] neg_lo:[0,1] neg_hi:[0,1]
    v_pk_add_f32 v[80:81], v[26:27], v[68:69] neg_lo:[0,1] neg_hi:[0,1]
    v_pk_add_f32 v[26:27], v[26:27], v[68:69]
    v_pk_add_f32 v[30:31], v[30:31], v[72:73]
    v_pk_add_f32 v[78:79], v[32:33], v[74:75] neg_lo:[0,1] neg_hi:[0,1]
    v_pk_add_f32 v[82:83], v[28:29], v[70:71] neg_lo:[0,1] neg_hi:[0,1]
    v_pk_add_f32 v[28:29], v[28:29], v[70:71]
    v_pk_add_f32 v[32:33], v[32:33], v[74:75]
    v_pk_fma_f32 v[152:153], v[240:241], v[76:77], v[152:153]
    buffer_load_dwordx4 a[32:35], v4, s[56:59], s16 offen offset:0
    v_pk_fma_f32 v[154:155], v[242:243], v[78:79], v[154:155]
    v_pk_fma_f32 v[156:157], v[244:245], v[80:81], v[156:157]
    v_pk_fma_f32 v[158:159], v[246:247], v[82:83], v[158:159]
    v_pk_fma_f32 v[160:161], v[250:251], v[26:27], v[160:161] op_sel:[1,0,0] op_sel_hi:[0,1,1]
    v_pk_fma_f32 v[162:163], v[248:249], v[28:29], v[162:163] op_sel:[1,0,0] op_sel_hi:[0,1,1]
    v_pk_fma_f32 v[164:165], v[254:255], v[30:31], v[164:165] op_sel:[1,0,0] op_sel_hi:[0,1,1]
    v_pk_fma_f32 v[166:167], v[252:253], v[32:33], v[166:167] op_sel:[1,0,0] op_sel_hi:[0,1,1]
    v_pk_fma_f32 v[24:25], v[152:153], v[152:153], v[24:25]
    v_pk_add_f32 v[22:23], v[22:23], v[152:153]
    v_pk_fma_f32 v[24:25], v[154:155], v[154:155], v[24:25]
    v_pk_add_f32 v[22:23], v[22:23], v[154:155]
    v_pk_fma_f32 v[24:25], v[156:157], v[156:157], v[24:25]
    v_pk_add_f32 v[22:23], v[22:23], v[156:157]
    v_pk_fma_f32 v[24:25], v[158:159], v[158:159], v[24:25]
    v_pk_add_f32 v[22:23], v[22:23], v[158:159]
    buffer_load_dwordx4 a[36:39], v4, s[56:59], s17 offen offset:0
    v_pk_fma_f32 v[24:25], v[160:161], v[160:161], v[24:25]
    v_pk_add_f32 v[22:23], v[22:23], v[160:161]
    v_pk_fma_f32 v[24:25], v[162:163], v[162:163], v[24:25]
    v_pk_add_f32 v[22:23], v[22:23], v[162:163]
    v_pk_fma_f32 v[24:25], v[164:165], v[164:165], v[24:25]
    v_pk_add_f32 v[22:23], v[22:23], v[164:165]
    v_pk_fma_f32 v[24:25], v[166:167], v[166:167], v[24:25]
    v_pk_add_f32 v[22:23], v[22:23], v[166:167]
    buffer_load_dwordx4 a[40:43], v4, s[56:59], s16 offen offset:1024
    s_add_u32 s16, s16, 8192
    s_branch ad_both_38
ad_one_37:
    s_nop 1
    v_pk_add_f32 v[26:27], v[52:53], v[56:57]
    buffer_load_dwordx4 a[4:7], v4, s[56:59], s17 offen offset:0
    v_pk_add_f32 v[30:31], v[52:53], v[56:57] neg_lo:[0,1] neg_hi:[0,1]
    v_pk_add_f32 v[28:29], v[54:55], v[58:59]
    v_pk_add_f32 v[32:33], v[54:55], v[58:59] neg_lo:[0,1] neg_hi:[0,1]
    v_pk_add_f32 v[52:53], v[60:61], v[64:65]
    v_pk_add_f32 v[56:57], v[60:61], v[64:65] neg_lo:[0,1] neg_hi:[0,1]
    v_pk_add_f32 v[54:55], v[62:63], v[66:67]
    v_pk_add_f32 v[58:59], v[62:63], v[66:67] neg_lo:[0,1] neg_hi:[0,1]
    v_pk_add_f32 v[60:61], v[30:31], v[56:57] neg_lo:[0,1] neg_hi:[0,1]
    buffer_load_dwordx4 a[8:11], v4, s[56:59], s16 offen offset:1024
    s_add_u32 s16, s16, 8192
    v_pk_add_f32 v[64:65], v[26:27], v[52:53] neg_lo:[0,1] neg_hi:[0,1]
    v_pk_add_f32 v[26:27], v[26:27], v[52:53]
    v_pk_add_f32 v[30:31], v[30:31], v[56:57]
    v_pk_add_f32 v[62:63], v[32:33], v[58:59] neg_lo:[0,1] neg_hi:[0,1]
    v_pk_add_f32 v[66:67], v[28:29], v[54:55] neg_lo:[0,1] neg_hi:[0,1]
    v_pk_add_f32 v[28:29], v[28:29], v[54:55]
    v_pk_add_f32 v[32:33], v[32:33], v[58:59]
    v_pk_fma_f32 v[136:137], v[224:225], v[60:61], v[136:137]
    buffer_load_dwordx4 a[12:15], v4, s[56:59], s17 offen offset:1024
    s_add_u32 s17, s17, 8192
    v_pk_fma_f32 v[138:139], v[226:227], v[62:63], v[138:139]
    v_pk_fma_f32 v[140:141], v[228:229], v[64:65], v[140:141]
    v_pk_fma_f32 v[142:143], v[230:231], v[66:67], v[142:143]
    v_pk_fma_f32 v[144:145], v[234:235], v[26:27], v[144:145] op_sel:[1,0,0] op_sel_hi:[0,1,1]
    v_pk_fma_f32 v[146:147], v[232:233], v[28:29], v[146:147] op_sel:[1,0,0] op_sel_hi:[0,1,1]
    v_pk_fma_f32 v[148:149], v[238:239], v[30:31], v[148:149] op_sel:[1,0,0] op_sel_hi:[0,1,1]
    v_pk_fma_f32 v[150:151], v[236:237], v[32:33], v[150:151] op_sel:[1,0,0] op_sel_hi:[0,1,1]
    v_pk_mul_f32 v[24:25], v[136:137], v[136:137]
    buffer_load_dwordx4 a[16:19], v4, s[56:59], s16 offen offset:0
    v_pk_add_f32 v[22:23], v[136:137], v[138:139]
    v_pk_fma_f32 v[24:25], v[138:139], v[138:139], v[24:25]
    v_pk_fma_f32 v[24:25], v[140:141], v[140:141], v[24:25]
    v_pk_add_f32 v[22:23], v[22:23], v[140:141]
    v_pk_fma_f32 v[24:25], v[142:143], v[142:143], v[24:25]
    v_pk_add_f32 v[22:23], v[22:23], v[142:143]
    v_pk_fma_f32 v[24:25], v[144:145], v[144:145], v[24:25]
    v_pk_add_f32 v[22:23], v[22:23], v[144:145]
    buffer_load_dwordx4 a[20:23], v4, s[56:59], s17 offen offset:0
    v_pk_fma_f32 v[24:25], v[146:147], v[146:147], v[24:25]
    v_pk_add_f32 v[22:23], v[22:23], v[146:147]
    v_pk_fma_f32 v[24:25], v[148:149], v[148:149], v[24:25]
    v_pk_add_f32 v[22:23], v[22:23], v[148:149]
    v_pk_fma_f32 v[24:25], v[150:151], v[150:151], v[24:25]
    v_pk_add_f32 v[22:23], v[22:23], v[150:151]
    buffer_load_dwordx4 a[24:27], v4, s[56:59], s16 offen offset:1024
    s_add_u32 s16, s16, 8192
    buffer_load_dwordx4 a[28:31], v4, s[56:59], s17 offen offset:1024
    s_add_u32 s17, s17, 8192
    buffer_load_dwordx4 a[32:35], v4, s[56:59], s16 offen offset:0
    buffer_load_dwordx4 a[36:39], v4, s[56:59], s17 offen offset:0
    buffer_load_dwordx4 a[40:43], v4, s[56:59], s16 offen offset:1024
    s_add_u32 s16, s16, 8192
ad_both_38:
    v_add_f32 v22, v22, v23
    v_add_f32 v23, v24, v25
    ds_read_b128 v[224:227], v41 offset:1792
    ds_read_b128 v[228:231], v41 offset:2688
    ds_read_b128 v[232:235], v42 offset:2048
    ds_read_b128 v[236:239], v42 offset:2944
    ds_read_b128 v[240:243], v41 offset:3584
    ds_read_b128 v[244:247], v41 offset:4480
    ds_read_b128 v[248:251], v42 offset:3840
    ds_read_b128 v[252:255], v42 offset:4736
    v_mov_b32 v6, v22
    s_nop 1
    v_permlane16_swap_b32 v22, v6
    v_add_f32 v22, v22, v6
    v_mov_b32 v7, v23
    s_nop 1
    v_permlane16_swap_b32 v23, v7
    v_add_f32 v23, v23, v7
    v_mov_b32 v6, v22
    s_nop 1
    v_permlane32_swap_b32 v22, v6
    v_add_f32 v22, v22, v6
    v_mov_b32 v7, v23
    s_nop 1
    v_permlane32_swap_b32 v23, v7
    v_add_f32 v23, v23, v7
    ds_write_b64 v45, v[22:23]
    s_cmp_lg_u32 s34, 0
    s_cbranch_scc1 ad_skx_39
    v_cvt_pk_bf16_f32 v176, v136, v137
    v_cvt_pk_bf16_f32 v177, v138, v139
    ds_write_b64 v47, v[176:177] offset:0
    v_cvt_pk_bf16_f32 v178, v140, v141
    v_cvt_pk_bf16_f32 v179, v142, v143
    ds_write_b64 v47, v[178:179] offset:448
    v_cvt_pk_bf16_f32 v180, v147, v146
    v_cvt_pk_bf16_f32 v181, v145, v144
    ds_write_b64 v48, v[180:181] offset:128
    v_cvt_pk_bf16_f32 v182, v151, v150
    v_cvt_pk_bf16_f32 v183, v149, v148
    ds_write_b64 v48, v[182:183] offset:576
    s_cmp_eq_u32 s22, 3
    s_cbranch_scc1 ad_skx_39
    v_cvt_pk_bf16_f32 v184, v152, v153
    v_cvt_pk_bf16_f32 v185, v154, v155
    ds_write_b64 v47, v[184:185] offset:128
    v_cvt_pk_bf16_f32 v186, v156, v157
    v_cvt_pk_bf16_f32 v187, v158, v159
    ds_write_b64 v47, v[186:187] offset:576
    v_cvt_pk_bf16_f32 v188, v163, v162
    v_cvt_pk_bf16_f32 v189, v161, v160
    ds_write_b64 v48, v[188:189] offset:0
    v_cvt_pk_bf16_f32 v190, v167, v166
    v_cvt_pk_bf16_f32 v191, v165, v164
    ds_write_b64 v48, v[190:191] offset:448
ad_skx_39:
    buffer_load_dwordx4 a[44:47], v4, s[56:59], s17 offen offset:1024
    s_add_u32 s17, s17, 8192
    s_waitcnt lgkmcnt(0)
    s_barrier
    ds_read_b64 v[216:217], v44 offset:0
    ds_read_b64 v[218:219], v44 offset:128
    ds_read_b64 v[220:221], v44 offset:256
    ds_read_b64 v[222:223], v44 offset:384
    ds_read_b128 a[48:51], v49 offset:0
    ds_read_b128 a[52:55], v49 offset:912
    ds_read_b128 a[56:59], v49 offset:1824
    ds_read_b128 a[60:63], v49 offset:2736
    s_waitcnt lgkmcnt(6)
    v_pk_add_f32 v[216:217], v[216:217], v[218:219]
    s_waitcnt lgkmcnt(4)
    v_pk_add_f32 v[220:221], v[220:221], v[222:223]
    v_pk_add_f32 v[216:217], v[216:217], v[220:221]
    s_mov_b32 s26, 0x3b124925
    v_mul_f32 v216, s26, v216
    v_mul_f32 v6, v216, v216
    v_fma_f32 v217, v217, s26, -v6
    v_max_f32 v217, 0, v217
    v_add_f32 v217, 0x3727c5ac, v217
    v_rsq_f32 v217, v217
    s_nop 0
    v_mul_f32 v216, -v216, v217
    s_cmp_lg_u32 s34, 0
    s_cbranch_scc1 ad_h1_40
    v_pk_fma_f32 v[176:177], v[136:137], v[216:217], v[216:217] op_sel:[0,1,0] op_sel_hi:[1,1,0]
    v_pk_fma_f32 v[178:179], v[138:139], v[216:217], v[216:217] op_sel:[0,1,0] op_sel_hi:[1,1,0]
    v_pk_fma_f32 v[180:181], v[140:141], v[216:217], v[216:217] op_sel:[0,1,0] op_sel_hi:[1,1,0]
    v_pk_fma_f32 v[182:183], v[142:143], v[216:217], v[216:217] op_sel:[0,1,0] op_sel_hi:[1,1,0]
    v_pk_fma_f32 v[184:185], v[144:145], v[216:217], v[216:217] op_sel:[0,1,0] op_sel_hi:[1,1,0]
    v_pk_fma_f32 v[186:187], v[146:147], v[216:217], v[216:217] op_sel:[0,1,0] op_sel_hi:[1,1,0]
    v_pk_fma_f32 v[188:189], v[148:149], v[216:217], v[216:217] op_sel:[0,1,0] op_sel_hi:[1,1,0]
    v_pk_fma_f32 v[190:191], v[150:151], v[216:217], v[216:217] op_sel:[0,1,0] op_sel_hi:[1,1,0]
    v_pk_fma_f32 v[176:177], v[176:177], v[240:241], v[224:225]
    v_pk_fma_f32 v[178:179], v[178:179], v[242:243], v[226:227]
    v_pk_fma_f32 v[180:181], v[180:181], v[244:245], v[228:229]
    v_pk_fma_f32 v[182:183], v[182:183], v[246:247], v[230:231]
    v_pk_fma_f32 v[184:185], v[184:185], v[250:251], v[234:235] op_sel:[0,1,1] op_sel_hi:[1,0,0]
    v_pk_fma_f32 v[186:187], v[186:187], v[248:249], v[232:233] op_sel:[0,1,1] op_sel_hi:[1,0,0]
    v_pk_fma_f32 v[188:189], v[188:189], v[254:255], v[238:239] op_sel:[0,1,1] op_sel_hi:[1,0,0]
    v_pk_fma_f32 v[190:191], v[190:191], v[252:253], v[236:237] op_sel:[0,1,1] op_sel_hi:[1,0,0]
    v_cvt_pk_bf16_f32 v208, v176, v177
    v_cvt_pk_bf16_f32 v209, v178, v179
    v_cvt_pk_bf16_f32 v210, v180, v181
    v_cvt_pk_bf16_f32 v211, v182, v183
    buffer_store_dwordx4 v[208:211], v46, s[52:55], s10 offen offset:0 sc1
    v_cvt_pk_bf16_f32 v212, v188, v189
    v_cvt_pk_bf16_f32 v213, v190, v191
    v_cvt_pk_bf16_f32 v214, v184, v185
    v_cvt_pk_bf16_f32 v215, v186, v187
    buffer_store_dwordx4 v[212:215], v46, s[52:55], s10 offen offset:2048 sc1
    s_branch ad_hd_41
ad_h1_40:
    s_cmp_eq_u32 s22, 3
    s_cbranch_scc1 ad_hd_41
    v_pk_fma_f32 v[176:177], v[152:153], v[216:217], v[216:217] op_sel:[0,1,0] op_sel_hi:[1,1,0]
    v_pk_fma_f32 v[178:179], v[154:155], v[216:217], v[216:217] op_sel:[0,1,0] op_sel_hi:[1,1,0]
    v_pk_fma_f32 v[180:181], v[156:157], v[216:217], v[216:217] op_sel:[0,1,0] op_sel_hi:[1,1,0]
    v_pk_fma_f32 v[182:183], v[158:159], v[216:217], v[216:217] op_sel:[0,1,0] op_sel_hi:[1,1,0]
    v_pk_fma_f32 v[184:185], v[160:161], v[216:217], v[216:217] op_sel:[0,1,0] op_sel_hi:[1,1,0]
    v_pk_fma_f32 v[186:187], v[162:163], v[216:217], v[216:217] op_sel:[0,1,0] op_sel_hi:[1,1,0]
    v_pk_fma_f32 v[188:189], v[164:165], v[216:217], v[216:217] op_sel:[0,1,0] op_sel_hi:[1,1,0]
    v_pk_fma_f32 v[190:191], v[166:167], v[216:217], v[216:217] op_sel:[0,1,0] op_sel_hi:[1,1,0]
    v_pk_fma_f32 v[176:177], v[176:177], v[240:241], v[224:225]
    v_pk_fma_f32 v[178:179], v[178:179], v[242:243], v[226:227]
    v_pk_fma_f32 v[180:181], v[180:181], v[244:245], v[228:229]
    v_pk_fma_f32 v[182:183], v[182:183], v[246:247], v[230:231]
    v_pk_fma_f32 v[184:185], v[184:185], v[250:251], v[234:235] op_sel:[0,1,1] op_sel_hi:[1,0,0]
    v_pk_fma_f32 v[186:187], v[186:187], v[248:249], v[232:233] op_sel:[0,1,1] op_sel_hi:[1,0,0]
    v_pk_fma_f32 v[188:189], v[188:189], v[254:255], v[238:239] op_sel:[0,1,1] op_sel_hi:[1,0,0]
    v_pk_fma_f32 v[190:191], v[190:191], v[252:253], v[236:237] op_sel:[0,1,1] op_sel_hi:[1,0,0]
    v_cvt_pk_bf16_f32 v208, v176, v177
    v_cvt_pk_bf16_f32 v209, v178, v179
    v_cvt_pk_bf16_f32 v210, v180, v181
    v_cvt_pk_bf16_f32 v211, v182, v183
    buffer_store_dwordx4 v[208:211], v46, s[52:55], s10 offen offset:0 sc1
    v_cvt_pk_bf16_f32 v212, v188, v189
    v_cvt_pk_bf16_f32 v213, v190, v191
    v_cvt_pk_bf16_f32 v214, v184, v185
    v_cvt_pk_bf16_f32 v215, v186, v187
    buffer_store_dwordx4 v[212:215], v46, s[52:55], s10 offen offset:2048 sc1
ad_hd_41:
    s_waitcnt lgkmcnt(3)
    buffer_store_dwordx4 a[48:51], v50, s[40:43], s12 offen sc1
    s_add_u32 s12, s12, 114688
    s_waitcnt lgkmcnt(2)
    buffer_store_dwordx4 a[52:55], v50, s[40:43], s12 offen sc1
    s_add_u32 s12, s12, 114688
    s_waitcnt lgkmcnt(1)
    buffer_store_dwordx4 a[56:59], v50, s[40:43], s12 offen sc1
    s_add_u32 s12, s12, 114688
    s_waitcnt lgkmcnt(0)
    buffer_store_dwordx4 a[60:63], v50, s[40:43], s12 offen sc1
    s_add_u32 s12, s12, 114688
    s_lshl_b32 s3, s35, 2
    s_add_u32 s3, s3, s22
    s_lshl_b32 s8, s3, 8
    s_lshl_b32 s25, s36, 2
    s_add_u32 s8, s8, s25
    s_add_u32 s8, s8, 0x2000
    s_lshl_b32 s9, s3, 6
    s_add_u32 s9, s9, 0x1000
    s_mul_i32 s3, s3, 28672
    s_add_u32 s3, s3, 0x1e4000
    v_lshlrev_b32 v13, 2, v1
    v_cmp_gt_u32 vcc, 16, v1
    s_nop 1
    v_cndmask_b32 v13, v8, v13, vcc
    v_cndmask_b32 v16, 0, v14, vcc
    s_mov_b32 s10, s3
    s_and_b32 s3, s2, 7
    s_bfe_u32 s25, s2, 0x10004
    s_lshl_b32 s25, s25, 3
    s_add_u32 s3, s3, s25
    s_lshl_b32 s3, s3, 2
    s_bfe_u32 s25, s2, 0x10003
    s_lshl_b32 s25, s25, 1
    s_add_u32 s3, s3, s25
    s_mul_i32 s13, s3, 114688
    s_lshl_b32 s25, s22, 11
    s_add_u32 s13, s13, s25
    s_add_u32 s13, s13, 0x3a4000
    s_waitcnt vmcnt(4)
    s_cmp_lg_u32 s24, 0
    s_cbranch_scc1 ad_pub_42
    buffer_store_dword v14, v10, s[52:55], s39 offen offset:0
ad_back_43:
    s_cmp_ge_u32 s2, 224
    s_cbranch_scc1 ad_end_1
    s_mov_b32 s28, 100000
ad_poll_44:
    buffer_load_dword v12, v13, s[52:55], s9 offen sc1
    s_waitcnt vmcnt(0)
    v_cmp_ne_u32 vcc, v12, v16
    s_nop 4
    s_cbranch_vccz ad_ok_45
    s_sleep 1
    s_sub_u32 s28, s28, 1
    s_cmp_lg_u32 s28, 0
    s_cbranch_scc1 ad_poll_44
ad_ok_45:
    buffer_load_dwordx4 v[144:147], v4, s[52:55], s10 offen offset:0 sc1
    buffer_load_dwordx4 v[148:151], v4, s[52:55], s10 offen offset:1024 sc1
    buffer_load_dwordx4 v[152:155], v4, s[52:55], s10 offen offset:2048 sc1
    buffer_load_dwordx4 v[156:159], v4, s[52:55], s10 offen offset:3072 sc1
    s_add_u32 s10, s10, 4096
    buffer_load_dwordx4 v[160:163], v4, s[52:55], s10 offen offset:0 sc1
    buffer_load_dwordx4 v[164:167], v4, s[52:55], s10 offen offset:1024 sc1
    buffer_load_dwordx4 v[168:171], v4, s[52:55], s10 offen offset:2048 sc1
    buffer_load_dwordx4 v[172:175], v4, s[52:55], s10 offen offset:3072 sc1
    s_add_u32 s10, s10, 4096
    buffer_load_dwordx4 v[176:179], v4, s[52:55], s10 offen offset:0 sc1
    v_bfe_u32 v6, v0, 3, 1
    v_lshlrev_b32 v6, 6, v6
    v_xor_b32 v11, v11, v6
    v_xor_b32 v17, 64, v11
    v_add_u32 v18, 57344, v11
    v_add_u32 v19, 57344, v17
    ds_read_b64_tr_b16 v[20:21], v11 offset:0
    ds_read_b64_tr_b16 v[22:23], v11 offset:512
    ds_read_b64_tr_b16 v[24:25], v17 offset:0
    ds_read_b64_tr_b16 v[26:27], v17 offset:512
    ds_read_b64_tr_b16 v[28:29], v11 offset:2048
    ds_read_b64_tr_b16 v[30:31], v11 offset:2560
    ds_read_b64_tr_b16 v[32:33], v17 offset:2048
    ds_read_b64_tr_b16 v[34:35], v17 offset:2560
    s_lshl_b32 s9, s3, 8
    s_add_u32 s9, s9, 0x2000
    v_lshlrev_b32 v13, 2, v2
    v_lshl_add_u32 v13, v3, 8, v13
    v_cmp_gt_u32 vcc, 14, v2
    s_nop 1
    v_cndmask_b32 v13, v8, v13, vcc
    v_cndmask_b32 v16, 0, v14, vcc
    v_cmp_gt_u32 vcc, 32, v1
    s_nop 1
    v_cndmask_b32 v13, v8, v13, vcc
    v_cndmask_b32 v16, 0, v16, vcc
    s_mov_b32 s28, 100000
    ds_read_b64_tr_b16 v[36:37], v11 offset:4096
    ds_read_b64_tr_b16 v[38:39], v11 offset:4608
    ds_read_b64_tr_b16 v[40:41], v17 offset:4096
    ds_read_b64_tr_b16 v[42:43], v17 offset:4608
    s_waitcnt lgkmcnt(8)
    s_waitcnt vmcnt(8)
    v_mfma_f32_32x32x16_bf16 v[128:143], v[20:23], v[144:147], 0
    buffer_load_dwordx4 v[180:183], v4, s[52:55], s10 offen offset:1024 sc1
    v_mfma_f32_32x32x16_bf16 v[112:127], v[24:27], v[144:147], 0
    ds_read_b64_tr_b16 v[20:21], v11 offset:6144
    ds_read_b64_tr_b16 v[22:23], v11 offset:6656
    ds_read_b64_tr_b16 v[24:25], v17 offset:6144
    ds_read_b64_tr_b16 v[26:27], v17 offset:6656
    s_waitcnt lgkmcnt(8)
    s_waitcnt vmcnt(8)
    v_mfma_f32_32x32x16_bf16 v[128:143], v[28:31], v[148:151], v[128:143]
    buffer_load_dwordx4 v[184:187], v4, s[52:55], s10 offen offset:2048 sc1
    v_mfma_f32_32x32x16_bf16 v[112:127], v[32:35], v[148:151], v[112:127]
    ds_read_b64_tr_b16 v[28:29], v11 offset:8192
    ds_read_b64_tr_b16 v[30:31], v11 offset:8704
    ds_read_b64_tr_b16 v[32:33], v17 offset:8192
    ds_read_b64_tr_b16 v[34:35], v17 offset:8704
    s_waitcnt lgkmcnt(8)
    s_waitcnt vmcnt(8)
    v_mfma_f32_32x32x16_bf16 v[128:143], v[36:39], v[152:155], v[128:143]
    buffer_load_dwordx4 v[188:191], v4, s[52:55], s10 offen offset:3072 sc1
    s_add_u32 s10, s10, 4096
    v_mfma_f32_32x32x16_bf16 v[112:127], v[40:43], v[152:155], v[112:127]
    ds_read_b64_tr_b16 v[36:37], v11 offset:10240
    ds_read_b64_tr_b16 v[38:39], v11 offset:10752
    ds_read_b64_tr_b16 v[40:41], v17 offset:10240
    ds_read_b64_tr_b16 v[42:43], v17 offset:10752
    s_waitcnt lgkmcnt(8)
    s_waitcnt vmcnt(8)
    v_mfma_f32_32x32x16_bf16 v[128:143], v[20:23], v[156:159], v[128:143]
    buffer_load_dwordx4 v[192:195], v4, s[52:55], s10 offen offset:0 sc1
    v_mfma_f32_32x32x16_bf16 v[112:127], v[24:27], v[156:159], v[112:127]
    ds_read_b64_tr_b16 v[20:21], v11 offset:12288
    ds_read_b64_tr_b16 v[22:23], v11 offset:12800
    ds_read_b64_tr_b16 v[24:25], v17 offset:12288
    ds_read_b64_tr_b16 v[26:27], v17 offset:12800
    s_waitcnt lgkmcnt(8)
    s_waitcnt vmcnt(8)
    v_mfma_f32_32x32x16_bf16 v[128:143], v[28:31], v[160:163], v[128:143]
    buffer_load_dwordx4 v[196:199], v4, s[52:55], s10 offen offset:1024 sc1
    v_mfma_f32_32x32x16_bf16 v[112:127], v[32:35], v[160:163], v[112:127]
    ds_read_b64_tr_b16 v[28:29], v11 offset:14336
    ds_read_b64_tr_b16 v[30:31], v11 offset:14848
    ds_read_b64_tr_b16 v[32:33], v17 offset:14336
    ds_read_b64_tr_b16 v[34:35], v17 offset:14848
    s_waitcnt lgkmcnt(8)
    s_waitcnt vmcnt(8)
    v_mfma_f32_32x32x16_bf16 v[128:143], v[36:39], v[164:167], v[128:143]
    buffer_load_dwordx4 v[200:203], v4, s[52:55], s10 offen offset:2048 sc1
    v_mfma_f32_32x32x16_bf16 v[112:127], v[40:43], v[164:167], v[112:127]
    ds_read_b64_tr_b16 v[36:37], v11 offset:16384
    ds_read_b64_tr_b16 v[38:39], v11 offset:16896
    ds_read_b64_tr_b16 v[40:41], v17 offset:16384
    ds_read_b64_tr_b16 v[42:43], v17 offset:16896
    s_waitcnt lgkmcnt(8)
    s_waitcnt vmcnt(8)
    v_mfma_f32_32x32x16_bf16 v[128:143], v[20:23], v[168:171], v[128:143]
    buffer_load_dwordx4 v[204:207], v4, s[52:55], s10 offen offset:3072 sc1
    s_add_u32 s10, s10, 4096
    v_mfma_f32_32x32x16_bf16 v[112:127], v[24:27], v[168:171], v[112:127]
    ds_read_b64_tr_b16 v[20:21], v11 offset:18432
    ds_read_b64_tr_b16 v[22:23], v11 offset:18944
    ds_read_b64_tr_b16 v[24:25], v17 offset:18432
    ds_read_b64_tr_b16 v[26:27], v17 offset:18944
    s_waitcnt lgkmcnt(8)
    s_waitcnt vmcnt(8)
    v_mfma_f32_32x32x16_bf16 v[128:143], v[28:31], v[172:175], v[128:143]
    buffer_load_dwordx4 v[208:211], v4, s[52:55], s10 offen offset:0 sc1
    v_mfma_f32_32x32x16_bf16 v[112:127], v[32:35], v[172:175], v[112:127]
    ds_read_b64_tr_b16 v[28:29], v11 offset:20480
    ds_read_b64_tr_b16 v[30:31], v11 offset:20992
    ds_read_b64_tr_b16 v[32:33], v17 offset:20480
    ds_read_b64_tr_b16 v[34:35], v17 offset:20992
    s_waitcnt lgkmcnt(8)
    s_waitcnt vmcnt(8)
    v_mfma_f32_32x32x16_bf16 v[128:143], v[36:39], v[176:179], v[128:143]
    buffer_load_dwordx4 v[212:215], v4, s[52:55], s10 offen offset:1024 sc1
    v_mfma_f32_32x32x16_bf16 v[112:127], v[40:43], v[176:179], v[112:127]
    ds_read_b64_tr_b16 v[36:37], v11 offset:22528
    ds_read_b64_tr_b16 v[38:39], v11 offset:23040
    ds_read_b64_tr_b16 v[40:41], v17 offset:22528
    ds_read_b64_tr_b16 v[42:43], v17 offset:23040
    s_waitcnt lgkmcnt(8)
    s_waitcnt vmcnt(8)
    v_mfma_f32_32x32x16_bf16 v[128:143], v[20:23], v[180:183], v[128:143]
    buffer_load_dwordx4 v[216:219], v4, s[52:55], s10 offen offset:2048 sc1
    v_mfma_f32_32x32x16_bf16 v[112:127], v[24:27], v[180:183], v[112:127]
    ds_read_b64_tr_b16 v[20:21], v11 offset:24576
    ds_read_b64_tr_b16 v[22:23], v11 offset:25088
    ds_read_b64_tr_b16 v[24:25], v17 offset:24576
    ds_read_b64_tr_b16 v[26:27], v17 offset:25088
    s_waitcnt lgkmcnt(8)
    s_waitcnt vmcnt(8)
    v_mfma_f32_32x32x16_bf16 v[128:143], v[28:31], v[184:187], v[128:143]
    buffer_load_dwordx4 v[220:223], v4, s[52:55], s10 offen offset:3072 sc1
    s_add_u32 s10, s10, 4096
    v_mfma_f32_32x32x16_bf16 v[112:127], v[32:35], v[184:187], v[112:127]
    ds_read_b64_tr_b16 v[28:29], v11 offset:26624
    ds_read_b64_tr_b16 v[30:31], v11 offset:27136
    ds_read_b64_tr_b16 v[32:33], v17 offset:26624
    ds_read_b64_tr_b16 v[34:35], v17 offset:27136
    s_waitcnt lgkmcnt(8)
    s_waitcnt vmcnt(8)
    v_mfma_f32_32x32x16_bf16 v[128:143], v[36:39], v[188:191], v[128:143]
    buffer_load_dwordx4 v[224:227], v4, s[52:55], s10 offen offset:0 sc1
    v_mfma_f32_32x32x16_bf16 v[112:127], v[40:43], v[188:191], v[112:127]
    ds_read_b64_tr_b16 v[36:37], v11 offset:28672
    ds_read_b64_tr_b16 v[38:39], v11 offset:29184
    ds_read_b64_tr_b16 v[40:41], v17 offset:28672
    ds_read_b64_tr_b16 v[42:43], v17 offset:29184
    s_waitcnt lgkmcnt(8)
    s_waitcnt vmcnt(8)
    v_mfma_f32_32x32x16_bf16 v[128:143], v[20:23], v[192:195], v[128:143]
    buffer_load_dwordx4 v[228:231], v4, s[52:55], s10 offen offset:1024 sc1
    v_mfma_f32_32x32x16_bf16 v[112:127], v[24:27], v[192:195], v[112:127]
    ds_read_b64_tr_b16 v[20:21], v11 offset:30720
    ds_read_b64_tr_b16 v[22:23], v11 offset:31232
    ds_read_b64_tr_b16 v[24:25], v17 offset:30720
    ds_read_b64_tr_b16 v[26:27], v17 offset:31232
    s_waitcnt lgkmcnt(8)
    s_waitcnt vmcnt(8)
    v_mfma_f32_32x32x16_bf16 v[128:143], v[28:31], v[196:199], v[128:143]
    buffer_load_dwordx4 v[232:235], v4, s[52:55], s10 offen offset:2048 sc1
    buffer_load_dwordx4 a[48:51], v4, s[56:59], s16 offen offset:0
    v_mfma_f32_32x32x16_bf16 v[112:127], v[32:35], v[196:199], v[112:127]
    ds_read_b64_tr_b16 v[28:29], v11 offset:32768
    ds_read_b64_tr_b16 v[30:31], v11 offset:33280
    ds_read_b64_tr_b16 v[32:33], v17 offset:32768
    ds_read_b64_tr_b16 v[34:35], v17 offset:33280
    s_waitcnt lgkmcnt(8)
    s_waitcnt vmcnt(9)
    v_mfma_f32_32x32x16_bf16 v[128:143], v[36:39], v[200:203], v[128:143]
    buffer_load_dwordx4 v[236:239], v4, s[52:55], s10 offen offset:3072 sc1
    s_add_u32 s10, s10, 4096
    buffer_load_dwordx4 a[52:55], v4, s[56:59], s17 offen offset:0
    v_mfma_f32_32x32x16_bf16 v[112:127], v[40:43], v[200:203], v[112:127]
    ds_read_b64_tr_b16 v[36:37], v11 offset:34816
    ds_read_b64_tr_b16 v[38:39], v11 offset:35328
    ds_read_b64_tr_b16 v[40:41], v17 offset:34816
    ds_read_b64_tr_b16 v[42:43], v17 offset:35328
    s_waitcnt lgkmcnt(8)
    s_waitcnt vmcnt(10)
    v_mfma_f32_32x32x16_bf16 v[128:143], v[20:23], v[204:207], v[128:143]
    buffer_load_dwordx4 v[240:243], v4, s[52:55], s10 offen offset:0 sc1
    buffer_load_dwordx4 a[56:59], v4, s[56:59], s16 offen offset:1024
    s_add_u32 s16, s16, 8192
    v_mfma_f32_32x32x16_bf16 v[112:127], v[24:27], v[204:207], v[112:127]
    ds_read_b64_tr_b16 v[20:21], v11 offset:36864
    ds_read_b64_tr_b16 v[22:23], v11 offset:37376
    ds_read_b64_tr_b16 v[24:25], v17 offset:36864
    ds_read_b64_tr_b16 v[26:27], v17 offset:37376
    s_waitcnt lgkmcnt(8)
    s_waitcnt vmcnt(11)
    v_mfma_f32_32x32x16_bf16 v[128:143], v[28:31], v[208:211], v[128:143]
    buffer_load_dwordx4 v[244:247], v4, s[52:55], s10 offen offset:1024 sc1
    buffer_load_dwordx4 a[60:63], v4, s[56:59], s17 offen offset:1024
    s_add_u32 s17, s17, 8192
    v_mfma_f32_32x32x16_bf16 v[112:127], v[32:35], v[208:211], v[112:127]
    ds_read_b64_tr_b16 v[28:29], v11 offset:38912
    ds_read_b64_tr_b16 v[30:31], v11 offset:39424
    ds_read_b64_tr_b16 v[32:33], v17 offset:38912
    ds_read_b64_tr_b16 v[34:35], v17 offset:39424
    s_waitcnt lgkmcnt(8)
    s_waitcnt vmcnt(12)
    v_mfma_f32_32x32x16_bf16 v[128:143], v[36:39], v[212:215], v[128:143]
    buffer_load_dwordx4 v[248:251], v4, s[52:55], s10 offen offset:2048 sc1
    buffer_load_dwordx4 a[64:67], v4, s[56:59], s16 offen offset:0
    v_mfma_f32_32x32x16_bf16 v[112:127], v[40:43], v[212:215], v[112:127]
    ds_read_b64_tr_b16 v[36:37], v11 offset:40960
    ds_read_b64_tr_b16 v[38:39], v11 offset:41472
    ds_read_b64_tr_b16 v[40:41], v17 offset:40960
    ds_read_b64_tr_b16 v[42:43], v17 offset:41472
    s_waitcnt lgkmcnt(8)
    s_waitcnt vmcnt(13)
    v_mfma_f32_32x32x16_bf16 v[128:143], v[20:23], v[216:219], v[128:143]
    buffer_load_dwordx4 v[252:255], v4, s[52:55], s10 offen offset:3072 sc1
    s_add_u32 s10, s10, 4096
    buffer_load_dwordx4 a[68:71], v4, s[56:59], s17 offen offset:0
    v_mfma_f32_32x32x16_bf16 v[112:127], v[24:27], v[216:219], v[112:127]
    ds_read_b64_tr_b16 v[20:21], v11 offset:43008
    ds_read_b64_tr_b16 v[22:23], v11 offset:43520
    ds_read_b64_tr_b16 v[24:25], v17 offset:43008
    ds_read_b64_tr_b16 v[26:27], v17 offset:43520
    s_waitcnt lgkmcnt(8)
    s_waitcnt vmcnt(14)
    v_mfma_f32_32x32x16_bf16 v[128:143], v[28:31], v[220:223], v[128:143]
    buffer_load_dwordx4 a[72:75], v4, s[56:59], s16 offen offset:1024
    s_add_u32 s16, s16, 8192
    v_mfma_f32_32x32x16_bf16 v[112:127], v[32:35], v[220:223], v[112:127]
    ds_read_b64_tr_b16 v[28:29], v11 offset:45056
    ds_read_b64_tr_b16 v[30:31], v11 offset:45568
    ds_read_b64_tr_b16 v[32:33], v17 offset:45056
    ds_read_b64_tr_b16 v[34:35], v17 offset:45568
    s_waitcnt lgkmcnt(8)
    s_waitcnt vmcnt(14)
    v_mfma_f32_32x32x16_bf16 v[128:143], v[36:39], v[224:227], v[128:143]
    buffer_load_dwordx4 a[76:79], v4, s[56:59], s17 offen offset:1024
    s_add_u32 s17, s17, 8192
    v_mfma_f32_32x32x16_bf16 v[112:127], v[40:43], v[224:227], v[112:127]
    ds_read_b64_tr_b16 v[36:37], v11 offset:47104
    ds_read_b64_tr_b16 v[38:39], v11 offset:47616
    ds_read_b64_tr_b16 v[40:41], v17 offset:47104
    ds_read_b64_tr_b16 v[42:43], v17 offset:47616
    s_waitcnt lgkmcnt(8)
    s_waitcnt vmcnt(14)
    v_mfma_f32_32x32x16_bf16 v[128:143], v[20:23], v[228:231], v[128:143]
    buffer_load_dwordx4 a[80:83], v4, s[56:59], s16 offen offset:0
    v_mfma_f32_32x32x16_bf16 v[112:127], v[24:27], v[228:231], v[112:127]
    ds_read_b64_tr_b16 v[20:21], v11 offset:49152
    ds_read_b64_tr_b16 v[22:23], v11 offset:49664
    ds_read_b64_tr_b16 v[24:25], v17 offset:49152
    ds_read_b64_tr_b16 v[26:27], v17 offset:49664
    s_waitcnt lgkmcnt(8)
    s_waitcnt vmcnt(14)
    v_mfma_f32_32x32x16_bf16 v[128:143], v[28:31], v[232:235], v[128:143]
    buffer_load_dwordx4 a[84:87], v4, s[56:59], s17 offen offset:0
    v_mfma_f32_32x32x16_bf16 v[112:127], v[32:35], v[232:235], v[112:127]
    ds_read_b64_tr_b16 v[28:29], v11 offset:51200
    ds_read_b64_tr_b16 v[30:31], v11 offset:51712
    ds_read_b64_tr_b16 v[32:33], v17 offset:51200
    ds_read_b64_tr_b16 v[34:35], v17 offset:51712
    s_waitcnt lgkmcnt(8)
    s_waitcnt vmcnt(13)
    v_mfma_f32_32x32x16_bf16 v[128:143], v[36:39], v[236:239], v[128:143]
    buffer_load_dwordx4 a[88:91], v4, s[56:59], s16 offen offset:1024
    s_add_u32 s16, s16, 8192
    v_mfma_f32_32x32x16_bf16 v[112:127], v[40:43], v[236:239], v[112:127]
    ds_read_b64_tr_b16 v[36:37], v11 offset:53248
    ds_read_b64_tr_b16 v[38:39], v11 offset:53760
    ds_read_b64_tr_b16 v[40:41], v17 offset:53248
    ds_read_b64_tr_b16 v[42:43], v17 offset:53760
    s_waitcnt lgkmcnt(8)
    s_waitcnt vmcnt(12)
    v_mfma_f32_32x32x16_bf16 v[128:143], v[20:23], v[240:243], v[128:143]
    buffer_load_dwordx4 a[92:95], v4, s[56:59], s17 offen offset:1024
    s_add_u32 s17, s17, 8192
    v_mfma_f32_32x32x16_bf16 v[112:127], v[24:27], v[240:243], v[112:127]
    ds_read_b64_tr_b16 v[20:21], v11 offset:55296
    ds_read_b64_tr_b16 v[22:23], v11 offset:55808
    ds_read_b64_tr_b16 v[24:25], v17 offset:55296
    ds_read_b64_tr_b16 v[26:27], v17 offset:55808
    s_waitcnt lgkmcnt(8)
    s_waitcnt vmcnt(11)
    v_mfma_f32_32x32x16_bf16 v[128:143], v[28:31], v[244:247], v[128:143]
    buffer_load_dwordx4 a[96:99], v4, s[56:59], s16 offen offset:0
    v_mfma_f32_32x32x16_bf16 v[112:127], v[32:35], v[244:247], v[112:127]
    ds_read_b64_tr_b16 v[28:29], v18 offset:0
    ds_read_b64_tr_b16 v[30:31], v18 offset:512
    ds_read_b64_tr_b16 v[32:33], v18 offset:2048
    ds_read_b64_tr_b16 v[34:35], v18 offset:2560
    s_waitcnt lgkmcnt(8)
    s_waitcnt vmcnt(10)
    v_mfma_f32_32x32x16_bf16 v[128:143], v[36:39], v[248:251], v[128:143]
    buffer_load_dwordx4 a[100:103], v4, s[56:59], s17 offen offset:0
    v_mfma_f32_32x32x16_bf16 v[112:127], v[40:43], v[248:251], v[112:127]
    ds_read_b64_tr_b16 v[36:37], v18 offset:4096
    ds_read_b64_tr_b16 v[38:39], v18 offset:4608
    ds_read_b64_tr_b16 v[40:41], v18 offset:6144
    ds_read_b64_tr_b16 v[42:43], v18 offset:6656
    s_waitcnt lgkmcnt(8)
    s_waitcnt vmcnt(9)
    v_mfma_f32_32x32x16_bf16 v[128:143], v[20:23], v[252:255], v[128:143]
    buffer_load_dwordx4 a[104:107], v4, s[56:59], s16 offen offset:1024
    s_add_u32 s16, s16, 8192
    v_mfma_f32_32x32x16_bf16 v[112:127], v[24:27], v[252:255], v[112:127]
    ds_read_b64_tr_b16 v[20:21], v18 offset:8192
    ds_read_b64_tr_b16 v[22:23], v18 offset:8704
    ds_read_b64_tr_b16 v[24:25], v18 offset:10240
    ds_read_b64_tr_b16 v[26:27], v18 offset:10752
    s_waitcnt lgkmcnt(8)
    v_mfma_f32_32x32x16_bf16 v[96:111], v[28:31], v[144:147], 0
    buffer_load_dwordx4 a[108:111], v4, s[56:59], s17 offen offset:1024
    s_add_u32 s17, s17, 8192
    v_mfma_f32_32x32x16_bf16 v[96:111], v[32:35], v[148:151], v[96:111]
    v_exp_f32 v44, v128
    v_exp_f32 v45, v129
    v_add_f32 v44, 1.0, v44
    v_add_f32 v45, 1.0, v45
    ds_read_b64_tr_b16 v[28:29], v18 offset:12288
    ds_read_b64_tr_b16 v[30:31], v18 offset:12800
    ds_read_b64_tr_b16 v[32:33], v18 offset:14336
    ds_read_b64_tr_b16 v[34:35], v18 offset:14848
    s_waitcnt lgkmcnt(8)
    v_mfma_f32_32x32x16_bf16 v[96:111], v[36:39], v[152:155], v[96:111]
    buffer_load_dwordx4 a[112:115], v4, s[56:59], s16 offen offset:0
    v_rcp_f32 v44, v44
    v_rcp_f32 v45, v45
    v_mul_f32 v44, v128, v44
    v_mul_f32 v45, v129, v45
    v_cvt_pk_bf16_f32 v72, v44, v45
    v_mfma_f32_32x32x16_bf16 v[96:111], v[40:43], v[156:159], v[96:111]
    v_exp_f32 v46, v130
    v_exp_f32 v47, v131
    v_add_f32 v46, 1.0, v46
    v_add_f32 v47, 1.0, v47
    v_rcp_f32 v46, v46
    ds_read_b64_tr_b16 v[36:37], v18 offset:16384
    ds_read_b64_tr_b16 v[38:39], v18 offset:16896
    ds_read_b64_tr_b16 v[40:41], v18 offset:18432
    ds_read_b64_tr_b16 v[42:43], v18 offset:18944
    s_waitcnt lgkmcnt(8)
    v_mfma_f32_32x32x16_bf16 v[96:111], v[20:23], v[160:163], v[96:111]
    buffer_load_dwordx4 a[116:119], v4, s[56:59], s17 offen offset:0
    v_rcp_f32 v47, v47
    v_mul_f32 v46, v130, v46
    v_mul_f32 v47, v131, v47
    v_cvt_pk_bf16_f32 v73, v46, v47
    v_exp_f32 v44, v132
    v_mfma_f32_32x32x16_bf16 v[96:111], v[24:27], v[164:167], v[96:111]
    v_exp_f32 v45, v133
    v_add_f32 v44, 1.0, v44
    v_add_f32 v45, 1.0, v45
    v_rcp_f32 v44, v44
    v_rcp_f32 v45, v45
    ds_read_b64_tr_b16 v[20:21], v18 offset:20480
    ds_read_b64_tr_b16 v[22:23], v18 offset:20992
    ds_read_b64_tr_b16 v[24:25], v18 offset:22528
    ds_read_b64_tr_b16 v[26:27], v18 offset:23040
    s_waitcnt lgkmcnt(8)
    v_mfma_f32_32x32x16_bf16 v[96:111], v[28:31], v[168:171], v[96:111]
    buffer_load_dwordx4 a[120:123], v4, s[56:59], s16 offen offset:1024
    s_add_u32 s16, s16, 8192
    v_mul_f32 v44, v132, v44
    v_mul_f32 v45, v133, v45
    v_cvt_pk_bf16_f32 v74, v44, v45
    v_exp_f32 v46, v134
    v_exp_f32 v47, v135
    v_mfma_f32_32x32x16_bf16 v[96:111], v[32:35], v[172:175], v[96:111]
    v_add_f32 v46, 1.0, v46
    v_add_f32 v47, 1.0, v47
    v_rcp_f32 v46, v46
    v_rcp_f32 v47, v47
    v_mul_f32 v46, v134, v46
    ds_read_b64_tr_b16 v[28:29], v18 offset:24576
    ds_read_b64_tr_b16 v[30:31], v18 offset:25088
    ds_read_b64_tr_b16 v[32:33], v18 offset:26624
    ds_read_b64_tr_b16 v[34:35], v18 offset:27136
    s_waitcnt lgkmcnt(8)
    v_mfma_f32_32x32x16_bf16 v[96:111], v[36:39], v[176:179], v[96:111]
    buffer_load_dwordx4 a[124:127], v4, s[56:59], s17 offen offset:1024
    s_add_u32 s17, s17, 8192
    v_mul_f32 v47, v135, v47
    v_cvt_pk_bf16_f32 v75, v46, v47
    s_add_u32 s27, s11, 0
    buffer_store_dwordx4 v[72:75], v4, s[52:55], s27 offen offset:0 sc1
    v_exp_f32 v44, v136
    v_exp_f32 v45, v137
    v_mfma_f32_32x32x16_bf16 v[96:111], v[40:43], v[180:183], v[96:111]
    v_add_f32 v44, 1.0, v44
    v_add_f32 v45, 1.0, v45
    v_rcp_f32 v44, v44
    v_rcp_f32 v45, v45
    v_mul_f32 v44, v136, v44
    ds_read_b64_tr_b16 v[36:37], v18 offset:28672
    ds_read_b64_tr_b16 v[38:39], v18 offset:29184
    ds_read_b64_tr_b16 v[40:41], v18 offset:30720
    ds_read_b64_tr_b16 v[42:43], v18 offset:31232
    s_waitcnt lgkmcnt(8)
    v_mfma_f32_32x32x16_bf16 v[96:111], v[20:23], v[184:187], v[96:111]
    buffer_load_dwordx4 a[128:131], v4, s[56:59], s16 offen offset:0
    v_mul_f32 v45, v137, v45
    v_cvt_pk_bf16_f32 v76, v44, v45
    v_exp_f32 v46, v138
    v_exp_f32 v47, v139
    v_add_f32 v46, 1.0, v46
    v_mfma_f32_32x32x16_bf16 v[96:111], v[24:27], v[188:191], v[96:111]
    v_add_f32 v47, 1.0, v47
    v_rcp_f32 v46, v46
    v_rcp_f32 v47, v47
    v_mul_f32 v46, v138, v46
    v_mul_f32 v47, v139, v47
    ds_read_b64_tr_b16 v[20:21], v18 offset:32768
    ds_read_b64_tr_b16 v[22:23], v18 offset:33280
    ds_read_b64_tr_b16 v[24:25], v18 offset:34816
    ds_read_b64_tr_b16 v[26:27], v18 offset:35328
    s_waitcnt lgkmcnt(8)
    v_mfma_f32_32x32x16_bf16 v[96:111], v[28:31], v[192:195], v[96:111]
    buffer_load_dwordx4 a[132:135], v4, s[56:59], s17 offen offset:0
    v_cvt_pk_bf16_f32 v77, v46, v47
    v_exp_f32 v44, v140
    v_exp_f32 v45, v141
    v_add_f32 v44, 1.0, v44
    v_add_f32 v45, 1.0, v45
    v_mfma_f32_32x32x16_bf16 v[96:111], v[32:35], v[196:199], v[96:111]
    v_rcp_f32 v44, v44
    v_rcp_f32 v45, v45
    v_mul_f32 v44, v140, v44
    v_mul_f32 v45, v141, v45
    v_cvt_pk_bf16_f32 v78, v44, v45
    ds_read_b64_tr_b16 v[28:29], v18 offset:36864
    ds_read_b64_tr_b16 v[30:31], v18 offset:37376
    ds_read_b64_tr_b16 v[32:33], v18 offset:38912
    ds_read_b64_tr_b16 v[34:35], v18 offset:39424
    s_waitcnt lgkmcnt(8)
    v_mfma_f32_32x32x16_bf16 v[96:111], v[36:39], v[200:203], v[96:111]
    buffer_load_dwordx4 a[136:139], v4, s[56:59], s16 offen offset:1024
    s_add_u32 s16, s16, 8192
    v_exp_f32 v46, v142
    v_exp_f32 v47, v143
    v_add_f32 v46, 1.0, v46
    v_add_f32 v47, 1.0, v47
    v_rcp_f32 v46, v46
    v_mfma_f32_32x32x16_bf16 v[96:111], v[40:43], v[204:207], v[96:111]
    v_rcp_f32 v47, v47
    v_mul_f32 v46, v142, v46
    v_mul_f32 v47, v143, v47
    v_cvt_pk_bf16_f32 v79, v46, v47
    buffer_store_dwordx4 v[76:79], v4, s[52:55], s27 offen offset:1024 sc1
    ds_read_b64_tr_b16 v[36:37], v18 offset:40960
    ds_read_b64_tr_b16 v[38:39], v18 offset:41472
    ds_read_b64_tr_b16 v[40:41], v18 offset:43008
    ds_read_b64_tr_b16 v[42:43], v18 offset:43520
    s_waitcnt lgkmcnt(8)
    v_mfma_f32_32x32x16_bf16 v[96:111], v[20:23], v[208:211], v[96:111]
    buffer_load_dwordx4 a[140:143], v4, s[56:59], s17 offen offset:1024
    s_add_u32 s17, s17, 8192
    v_exp_f32 v44, v112
    v_exp_f32 v45, v113
    v_add_f32 v44, 1.0, v44
    v_add_f32 v45, 1.0, v45
    v_mfma_f32_32x32x16_bf16 v[96:111], v[24:27], v[212:215], v[96:111]
    v_rcp_f32 v44, v44
    v_rcp_f32 v45, v45
    v_mul_f32 v44, v112, v44
    v_mul_f32 v45, v113, v45
    v_cvt_pk_bf16_f32 v72, v44, v45
    ds_read_b64_tr_b16 v[20:21], v18 offset:45056
    ds_read_b64_tr_b16 v[22:23], v18 offset:45568
    ds_read_b64_tr_b16 v[24:25], v18 offset:47104
    ds_read_b64_tr_b16 v[26:27], v18 offset:47616
    s_waitcnt lgkmcnt(8)
    v_mfma_f32_32x32x16_bf16 v[96:111], v[28:31], v[216:219], v[96:111]
    v_exp_f32 v46, v114
    v_exp_f32 v47, v115
    v_add_f32 v46, 1.0, v46
    v_add_f32 v47, 1.0, v47
    v_rcp_f32 v46, v46
    v_mfma_f32_32x32x16_bf16 v[96:111], v[32:35], v[220:223], v[96:111]
    v_rcp_f32 v47, v47
    v_mul_f32 v46, v114, v46
    v_mul_f32 v47, v115, v47
    v_cvt_pk_bf16_f32 v73, v46, v47
    v_exp_f32 v44, v116
    ds_read_b64_tr_b16 v[28:29], v18 offset:49152
    ds_read_b64_tr_b16 v[30:31], v18 offset:49664
    ds_read_b64_tr_b16 v[32:33], v18 offset:51200
    ds_read_b64_tr_b16 v[34:35], v18 offset:51712
    s_waitcnt lgkmcnt(8)
    v_mfma_f32_32x32x16_bf16 v[96:111], v[36:39], v[224:227], v[96:111]
    v_exp_f32 v45, v117
    v_add_f32 v44, 1.0, v44
    v_add_f32 v45, 1.0, v45
    v_rcp_f32 v44, v44
    v_rcp_f32 v45, v45
    v_mfma_f32_32x32x16_bf16 v[96:111], v[40:43], v[228:231], v[96:111]
    v_mul_f32 v44, v116, v44
    v_mul_f32 v45, v117, v45
    v_cvt_pk_bf16_f32 v74, v44, v45
    v_exp_f32 v46, v118
    v_exp_f32 v47, v119
    ds_read_b64_tr_b16 v[36:37], v18 offset:53248
    ds_read_b64_tr_b16 v[38:39], v18 offset:53760
    ds_read_b64_tr_b16 v[40:41], v18 offset:55296
    ds_read_b64_tr_b16 v[42:43], v18 offset:55808
    s_waitcnt lgkmcnt(8)
    v_mfma_f32_32x32x16_bf16 v[96:111], v[20:23], v[232:235], v[96:111]
    v_add_f32 v46, 1.0, v46
    v_add_f32 v47, 1.0, v47
    v_rcp_f32 v46, v46
    v_rcp_f32 v47, v47
    v_mul_f32 v46, v118, v46
    v_mfma_f32_32x32x16_bf16 v[96:111], v[24:27], v[236:239], v[96:111]
    v_mul_f32 v47, v119, v47
    v_cvt_pk_bf16_f32 v75, v46, v47
    s_add_u32 s27, s11, 28672
    buffer_store_dwordx4 v[72:75], v4, s[52:55], s27 offen offset:0 sc1
    v_exp_f32 v44, v120
    v_exp_f32 v45, v121
    ds_read_b64_tr_b16 v[20:21], v19 offset:0
    ds_read_b64_tr_b16 v[22:23], v19 offset:512
    ds_read_b64_tr_b16 v[24:25], v19 offset:2048
    ds_read_b64_tr_b16 v[26:27], v19 offset:2560
    s_waitcnt lgkmcnt(8)
    v_mfma_f32_32x32x16_bf16 v[96:111], v[28:31], v[240:243], v[96:111]
    v_add_f32 v44, 1.0, v44
    v_add_f32 v45, 1.0, v45
    v_rcp_f32 v44, v44
    v_rcp_f32 v45, v45
    v_mul_f32 v44, v120, v44
    v_mfma_f32_32x32x16_bf16 v[96:111], v[32:35], v[244:247], v[96:111]
    v_mul_f32 v45, v121, v45
    v_cvt_pk_bf16_f32 v76, v44, v45
    v_exp_f32 v46, v122
    v_exp_f32 v47, v123
    v_add_f32 v46, 1.0, v46
    ds_read_b64_tr_b16 v[28:29], v19 offset:4096
    ds_read_b64_tr_b16 v[30:31], v19 offset:4608
    ds_read_b64_tr_b16 v[32:33], v19 offset:6144
    ds_read_b64_tr_b16 v[34:35], v19 offset:6656
    s_waitcnt lgkmcnt(8)
    v_mfma_f32_32x32x16_bf16 v[96:111], v[36:39], v[248:251], v[96:111]
    v_add_f32 v47, 1.0, v47
    v_rcp_f32 v46, v46
    v_rcp_f32 v47, v47
    v_mul_f32 v46, v122, v46
    v_mul_f32 v47, v123, v47
    v_mfma_f32_32x32x16_bf16 v[96:111], v[40:43], v[252:255], v[96:111]
    v_cvt_pk_bf16_f32 v77, v46, v47
    v_exp_f32 v44, v124
    v_exp_f32 v45, v125
    v_add_f32 v44, 1.0, v44
    v_add_f32 v45, 1.0, v45
    ds_read_b64_tr_b16 v[36:37], v19 offset:8192
    ds_read_b64_tr_b16 v[38:39], v19 offset:8704
    ds_read_b64_tr_b16 v[40:41], v19 offset:10240
    ds_read_b64_tr_b16 v[42:43], v19 offset:10752
    s_waitcnt lgkmcnt(8)
    v_mfma_f32_32x32x16_bf16 v[80:95], v[20:23], v[144:147], 0
    v_rcp_f32 v44, v44
    v_rcp_f32 v45, v45
    v_mul_f32 v44, v124, v44
    v_mul_f32 v45, v125, v45
    v_cvt_pk_bf16_f32 v78, v44, v45
    v_mfma_f32_32x32x16_bf16 v[80:95], v[24:27], v[148:151], v[80:95]
    v_exp_f32 v46, v126
    v_exp_f32 v47, v127
    v_add_f32 v46, 1.0, v46
    v_add_f32 v47, 1.0, v47
    v_rcp_f32 v46, v46
    ds_read_b64_tr_b16 v[20:21], v19 offset:12288
    ds_read_b64_tr_b16 v[22:23], v19 offset:12800
    ds_read_b64_tr_b16 v[24:25], v19 offset:14336
    ds_read_b64_tr_b16 v[26:27], v19 offset:14848
    s_waitcnt lgkmcnt(8)
    v_mfma_f32_32x32x16_bf16 v[80:95], v[28:31], v[152:155], v[80:95]
    v_rcp_f32 v47, v47
    v_mul_f32 v46, v126, v46
    v_mul_f32 v47, v127, v47
    v_cvt_pk_bf16_f32 v79, v46, v47
    buffer_store_dwordx4 v[76:79], v4, s[52:55], s27 offen offset:1024 sc1
    v_mfma_f32_32x32x16_bf16 v[80:95], v[32:35], v[156:159], v[80:95]
    v_exp_f32 v44, v96
    v_exp_f32 v45, v97
    ds_read_b64_tr_b16 v[28:29], v19 offset:16384
    ds_read_b64_tr_b16 v[30:31], v19 offset:16896
    ds_read_b64_tr_b16 v[32:33], v19 offset:18432
    ds_read_b64_tr_b16 v[34:35], v19 offset:18944
    s_waitcnt lgkmcnt(8)
    v_mfma_f32_32x32x16_bf16 v[80:95], v[36:39], v[160:163], v[80:95]
    v_add_f32 v44, 1.0, v44
    v_add_f32 v45, 1.0, v45
    v_rcp_f32 v44, v44
    v_mfma_f32_32x32x16_bf16 v[80:95], v[40:43], v[164:167], v[80:95]
    v_rcp_f32 v45, v45
    v_mul_f32 v44, v96, v44
    v_mul_f32 v45, v97, v45
    ds_read_b64_tr_b16 v[36:37], v19 offset:20480
    ds_read_b64_tr_b16 v[38:39], v19 offset:20992
    ds_read_b64_tr_b16 v[40:41], v19 offset:22528
    ds_read_b64_tr_b16 v[42:43], v19 offset:23040
    s_waitcnt lgkmcnt(8)
    v_mfma_f32_32x32x16_bf16 v[80:95], v[20:23], v[168:171], v[80:95]
    v_cvt_pk_bf16_f32 v72, v44, v45
    v_exp_f32 v46, v98
    v_exp_f32 v47, v99
    v_mfma_f32_32x32x16_bf16 v[80:95], v[24:27], v[172:175], v[80:95]
    v_add_f32 v46, 1.0, v46
    v_add_f32 v47, 1.0, v47
    v_rcp_f32 v46, v46
    ds_read_b64_tr_b16 v[20:21], v19 offset:24576
    ds_read_b64_tr_b16 v[22:23], v19 offset:25088
    ds_read_b64_tr_b16 v[24:25], v19 offset:26624
    ds_read_b64_tr_b16 v[26:27], v19 offset:27136
    s_waitcnt lgkmcnt(8)
    v_mfma_f32_32x32x16_bf16 v[80:95], v[28:31], v[176:179], v[80:95]
    v_rcp_f32 v47, v47
    v_mul_f32 v46, v98, v46
    v_mul_f32 v47, v99, v47
    v_mfma_f32_32x32x16_bf16 v[80:95], v[32:35], v[180:183], v[80:95]
    v_cvt_pk_bf16_f32 v73, v46, v47
    v_exp_f32 v44, v100
    v_exp_f32 v45, v101
    ds_read_b64_tr_b16 v[28:29], v19 offset:28672
    ds_read_b64_tr_b16 v[30:31], v19 offset:29184
    ds_read_b64_tr_b16 v[32:33], v19 offset:30720
    ds_read_b64_tr_b16 v[34:35], v19 offset:31232
    s_waitcnt lgkmcnt(8)
    v_mfma_f32_32x32x16_bf16 v[80:95], v[36:39], v[184:187], v[80:95]
    v_add_f32 v44, 1.0, v44
    v_add_f32 v45, 1.0, v45
    v_rcp_f32 v44, v44
    v_mfma_f32_32x32x16_bf16 v[80:95], v[40:43], v[188:191], v[80:95]
    v_rcp_f32 v45, v45
    v_mul_f32 v44, v100, v44
    ds_read_b64_tr_b16 v[36:37], v19 offset:32768
    ds_read_b64_tr_b16 v[38:39], v19 offset:33280
    ds_read_b64_tr_b16 v[40:41], v19 offset:34816
    ds_read_b64_tr_b16 v[42:43], v19 offset:35328
    s_waitcnt lgkmcnt(8)
    v_mfma_f32_32x32x16_bf16 v[80:95], v[20:23], v[192:195], v[80:95]
    v_mul_f32 v45, v101, v45
    v_cvt_pk_bf16_f32 v74, v44, v45
    v_exp_f32 v46, v102
    v_mfma_f32_32x32x16_bf16 v[80:95], v[24:27], v[196:199], v[80:95]
    v_exp_f32 v47, v103
    v_add_f32 v46, 1.0, v46
    v_add_f32 v47, 1.0, v47
    ds_read_b64_tr_b16 v[20:21], v19 offset:36864
    ds_read_b64_tr_b16 v[22:23], v19 offset:37376
    ds_read_b64_tr_b16 v[24:25], v19 offset:38912
    ds_read_b64_tr_b16 v[26:27], v19 offset:39424
    s_waitcnt lgkmcnt(8)
    v_mfma_f32_32x32x16_bf16 v[80:95], v[28:31], v[200:203], v[80:95]
    v_rcp_f32 v46, v46
    v_rcp_f32 v47, v47
    v_mul_f32 v46, v102, v46
    s_waitcnt vmcnt(0)
    s_cmp_lg_u32 s24, 0
    s_cbranch_scc1 ad_pub_46
    buffer_store_dword v14, v10, s[52:55], s8 offen offset:64
ad_back_47:
    buffer_load_dword v12, v13, s[52:55], s9 offen offset:64 sc1
    v_mfma_f32_32x32x16_bf16 v[80:95], v[32:35], v[204:207], v[80:95]
    v_mul_f32 v47, v103, v47
    v_cvt_pk_bf16_f32 v75, v46, v47
    v_exp_f32 v44, v104
    ds_read_b64_tr_b16 v[28:29], v19 offset:40960
    ds_read_b64_tr_b16 v[30:31], v19 offset:41472
    ds_read_b64_tr_b16 v[32:33], v19 offset:43008
    ds_read_b64_tr_b16 v[34:35], v19 offset:43520
    s_waitcnt lgkmcnt(8)
    v_mfma_f32_32x32x16_bf16 v[80:95], v[36:39], v[208:211], v[80:95]
    v_exp_f32 v45, v105
    v_add_f32 v44, 1.0, v44
    v_add_f32 v45, 1.0, v45
    v_mfma_f32_32x32x16_bf16 v[80:95], v[40:43], v[212:215], v[80:95]
    v_rcp_f32 v44, v44
    v_rcp_f32 v45, v45
    v_mul_f32 v44, v104, v44
    ds_read_b64_tr_b16 v[36:37], v19 offset:45056
    ds_read_b64_tr_b16 v[38:39], v19 offset:45568
    ds_read_b64_tr_b16 v[40:41], v19 offset:47104
    ds_read_b64_tr_b16 v[42:43], v19 offset:47616
    s_waitcnt lgkmcnt(8)
    v_mfma_f32_32x32x16_bf16 v[80:95], v[20:23], v[216:219], v[80:95]
    v_mul_f32 v45, v105, v45
    v_cvt_pk_bf16_f32 v76, v44, v45
    v_exp_f32 v46, v106
    v_mfma_f32_32x32x16_bf16 v[80:95], v[24:27], v[220:223], v[80:95]
    v_exp_f32 v47, v107
    v_add_f32 v46, 1.0, v46
    ds_read_b64_tr_b16 v[20:21], v19 offset:49152
    ds_read_b64_tr_b16 v[22:23], v19 offset:49664
    ds_read_b64_tr_b16 v[24:25], v19 offset:51200
    ds_read_b64_tr_b16 v[26:27], v19 offset:51712
    s_waitcnt lgkmcnt(8)
    v_mfma_f32_32x32x16_bf16 v[80:95], v[28:31], v[224:227], v[80:95]
    v_add_f32 v47, 1.0, v47
    v_rcp_f32 v46, v46
    v_rcp_f32 v47, v47
    v_mfma_f32_32x32x16_bf16 v[80:95], v[32:35], v[228:231], v[80:95]
    v_mul_f32 v46, v106, v46
    v_mul_f32 v47, v107, v47
    v_cvt_pk_bf16_f32 v77, v46, v47
    ds_read_b64_tr_b16 v[28:29], v19 offset:53248
    ds_read_b64_tr_b16 v[30:31], v19 offset:53760
    ds_read_b64_tr_b16 v[32:33], v19 offset:55296
    ds_read_b64_tr_b16 v[34:35], v19 offset:55808
    s_waitcnt lgkmcnt(8)
    v_mfma_f32_32x32x16_bf16 v[80:95], v[36:39], v[232:235], v[80:95]
    v_exp_f32 v44, v108
    v_exp_f32 v45, v109
    v_add_f32 v44, 1.0, v44
    v_mfma_f32_32x32x16_bf16 v[80:95], v[40:43], v[236:239], v[80:95]
    v_add_f32 v45, 1.0, v45
    v_rcp_f32 v44, v44
    v_rcp_f32 v45, v45
    s_waitcnt lgkmcnt(4)
    v_mfma_f32_32x32x16_bf16 v[80:95], v[20:23], v[240:243], v[80:95]
    v_mul_f32 v44, v108, v44
    v_mul_f32 v45, v109, v45
    v_cvt_pk_bf16_f32 v78, v44, v45
    v_mfma_f32_32x32x16_bf16 v[80:95], v[24:27], v[244:247], v[80:95]
    v_exp_f32 v46, v110
    v_exp_f32 v47, v111
    v_add_f32 v46, 1.0, v46
    s_waitcnt lgkmcnt(0)
    v_mfma_f32_32x32x16_bf16 v[80:95], v[28:31], v[248:251], v[80:95]
    v_add_f32 v47, 1.0, v47
    v_rcp_f32 v46, v46
    v_rcp_f32 v47, v47
    v_mfma_f32_32x32x16_bf16 v[80:95], v[32:35], v[252:255], v[80:95]
    v_mul_f32 v46, v110, v46
    v_mul_f32 v47, v111, v47
    v_cvt_pk_bf16_f32 v79, v46, v47
    s_nop 8
    v_exp_f32 v44, v80
    v_exp_f32 v46, v82
    v_exp_f32 v45, v81
    v_exp_f32 v47, v83
    v_pk_add_f32 v[44:45], v[44:45], 1.0 op_sel_hi:[1,0]
    v_pk_add_f32 v[46:47], v[46:47], 1.0 op_sel_hi:[1,0]
    v_rcp_f32 v44, v44
    v_rcp_f32 v46, v46
ad_again_48:
    s_waitcnt vmcnt(0)
    v_cmp_ne_u32 vcc, v12, v16
    s_nop 4
    s_cbranch_vccnz ad_stub_50
ad_ok_49:
    s_add_u32 s25, s13, 0
    buffer_load_dwordx4 a[144:147], v4, s[52:55], s25 offen offset:0 sc1
    buffer_load_dwordx4 a[148:151], v4, s[52:55], s25 offen offset:1024 sc1
    s_add_u32 s25, s13, 8192
    buffer_load_dwordx4 a[152:155], v4, s[52:55], s25 offen offset:0 sc1
    buffer_load_dwordx4 a[156:159], v4, s[52:55], s25 offen offset:1024 sc1
    s_add_u32 s25, s13, 16384
    buffer_load_dwordx4 a[160:163], v4, s[52:55], s25 offen offset:0 sc1
    buffer_load_dwordx4 a[164:167], v4, s[52:55], s25 offen offset:1024 sc1
    s_add_u32 s25, s13, 114688
    buffer_load_dwordx4 a[168:171], v4, s[52:55], s25 offen offset:0 sc1
    buffer_load_dwordx4 a[172:175], v4, s[52:55], s25 offen offset:1024 sc1
    s_add_u32 s25, s13, 122880
    buffer_load_dwordx4 v[128:131], v4, s[52:55], s25 offen offset:0 sc1
    buffer_load_dwordx4 v[132:135], v4, s[52:55], s25 offen offset:1024 sc1
    s_add_u32 s25, s13, 131072
    buffer_load_dwordx4 v[136:139], v4, s[52:55], s25 offen offset:0 sc1
    buffer_load_dwordx4 v[140:143], v4, s[52:55], s25 offen offset:1024 sc1
    s_add_u32 s25, s13, 24576
    buffer_load_dwordx4 v[112:115], v4, s[52:55], s25 offen offset:0 sc1
    buffer_load_dwordx4 v[116:119], v4, s[52:55], s25 offen offset:1024 sc1
    s_add_u32 s25, s13, 32768
    buffer_load_dwordx4 v[120:123], v4, s[52:55], s25 offen offset:0 sc1
    buffer_load_dwordx4 v[124:127], v4, s[52:55], s25 offen offset:1024 sc1
    s_add_u32 s27, s11, 57344
    buffer_store_dwordx4 v[72:75], v4, s[52:55], s27 offen offset:0 sc1
    buffer_store_dwordx4 v[76:79], v4, s[52:55], s27 offen offset:1024 sc1
    v_rcp_f32 v45, v45
    v_rcp_f32 v47, v47
    v_pk_mul_f32 v[44:45], v[80:81], v[44:45]
    v_pk_mul_f32 v[46:47], v[82:83], v[46:47]
    v_cvt_pk_bf16_f32 v96, v44, v45
    v_cvt_pk_bf16_f32 v97, v46, v47
    v_exp_f32 v44, v84
    v_exp_f32 v46, v86
    v_exp_f32 v45, v85
    v_exp_f32 v47, v87
    v_pk_add_f32 v[44:45], v[44:45], 1.0 op_sel_hi:[1,0]
    v_pk_add_f32 v[46:47], v[46:47], 1.0 op_sel_hi:[1,0]
    v_rcp_f32 v44, v44
    v_rcp_f32 v46, v46
    v_rcp_f32 v45, v45
    v_rcp_f32 v47, v47
    v_pk_mul_f32 v[44:45], v[84:85], v[44:45]
    v_pk_mul_f32 v[46:47], v[86:87], v[46:47]
    v_cvt_pk_bf16_f32 v98, v44, v45
    v_cvt_pk_bf16_f32 v99, v46, v47
    v_exp_f32 v44, v88
    v_exp_f32 v46, v90
    v_exp_f32 v45, v89
    v_exp_f32 v47, v91
    v_pk_add_f32 v[44:45], v[44:45], 1.0 op_sel_hi:[1,0]
    v_pk_add_f32 v[46:47], v[46:47], 1.0 op_sel_hi:[1,0]
    v_rcp_f32 v44, v44
    v_rcp_f32 v46, v46
    v_rcp_f32 v45, v45
    v_rcp_f32 v47, v47
    v_pk_mul_f32 v[44:45], v[88:89], v[44:45]
    v_pk_mul_f32 v[46:47], v[90:91], v[46:47]
    v_cvt_pk_bf16_f32 v100, v44, v45
    v_cvt_pk_bf16_f32 v101, v46, v47
    v_exp_f32 v44, v92
    v_exp_f32 v46, v94
    v_exp_f32 v45, v93
    v_exp_f32 v47, v95
    v_pk_add_f32 v[44:45], v[44:45], 1.0 op_sel_hi:[1,0]
    v_pk_add_f32 v[46:47], v[46:47], 1.0 op_sel_hi:[1,0]
    v_rcp_f32 v44, v44
    v_rcp_f32 v46, v46
    v_rcp_f32 v45, v45
    v_rcp_f32 v47, v47
    v_pk_mul_f32 v[44:45], v[92:93], v[44:45]
    v_pk_mul_f32 v[46:47], v[94:95], v[46:47]
    v_cvt_pk_bf16_f32 v102, v44, v45
    v_cvt_pk_bf16_f32 v103, v46, v47
    s_add_u32 s27, s11, 86016
    buffer_store_dwordx4 v[96:99], v4, s[52:55], s27 offen offset:0 sc1
    buffer_store_dwordx4 v[100:103], v4, s[52:55], s27 offen offset:1024 sc1
    s_waitcnt vmcnt(19)
    v_mfma_f32_32x32x16_bf16 v[144:159], a[176:179], a[144:147], 0
    v_mfma_f32_32x32x16_bf16 v[160:175], a[180:183], a[144:147], 0
    s_waitcnt vmcnt(18)
    v_mfma_f32_32x32x16_bf16 v[144:159], a[184:187], a[148:151], v[144:159]
    v_mfma_f32_32x32x16_bf16 v[160:175], a[188:191], a[148:151], v[160:175]
    s_add_u32 s25, s13, 40960
    buffer_load_dwordx4 v[208:211], v4, s[52:55], s25 offen offset:0 sc1
    buffer_load_dwordx4 v[212:215], v4, s[52:55], s25 offen offset:1024 sc1
    s_add_u32 s25, s13, 49152
    buffer_load_dwordx4 v[216:219], v4, s[52:55], s25 offen offset:0 sc1
    buffer_load_dwordx4 v[220:223], v4, s[52:55], s25 offen offset:1024 sc1
    s_waitcnt vmcnt(21)
    v_mfma_f32_32x32x16_bf16 v[144:159], a[192:195], a[152:155], v[144:159]
    v_mfma_f32_32x32x16_bf16 v[160:175], a[196:199], a[152:155], v[160:175]
    s_waitcnt vmcnt(20)
    v_mfma_f32_32x32x16_bf16 v[144:159], a[200:203], a[156:159], v[144:159]
    v_mfma_f32_32x32x16_bf16 v[160:175], a[204:207], a[156:159], v[160:175]
    s_add_u32 s25, s13, 139264
    buffer_load_dwordx4 v[224:227], v4, s[52:55], s25 offen offset:0 sc1
    buffer_load_dwordx4 v[228:231], v4, s[52:55], s25 offen offset:1024 sc1
    s_add_u32 s25, s13, 147456
    buffer_load_dwordx4 v[232:235], v4, s[52:55], s25 offen offset:0 sc1
    buffer_load_dwordx4 v[236:239], v4, s[52:55], s25 offen offset:1024 sc1
    s_waitcnt vmcnt(23)
    v_mfma_f32_32x32x16_bf16 v[144:159], a[208:211], a[160:163], v[144:159]
    v_mfma_f32_32x32x16_bf16 v[160:175], a[212:215], a[160:163], v[160:175]
    s_waitcnt vmcnt(22)
    v_mfma_f32_32x32x16_bf16 v[144:159], a[216:219], a[164:167], v[144:159]
    v_mfma_f32_32x32x16_bf16 v[160:175], a[220:223], a[164:167], v[160:175]
    s_add_u32 s25, s13, 155648
    buffer_load_dwordx4 v[240:243], v4, s[52:55], s25 offen offset:0 sc1
    buffer_load_dwordx4 v[244:247], v4, s[52:55], s25 offen offset:1024 sc1
    s_add_u32 s25, s13, 163840
    buffer_load_dwordx4 v[248:251], v4, s[52:55], s25 offen offset:0 sc1
    buffer_load_dwordx4 v[252:255], v4, s[52:55], s25 offen offset:1024 sc1
    s_waitcnt vmcnt(25)
    v_mfma_f32_32x32x16_bf16 v[176:191], a[176:179], a[168:171], 0
    v_mfma_f32_32x32x16_bf16 v[192:207], a[180:183], a[168:171], 0
    s_waitcnt vmcnt(24)
    v_mfma_f32_32x32x16_bf16 v[176:191], a[184:187], a[172:175], v[176:191]
    v_mfma_f32_32x32x16_bf16 v[192:207], a[188:191], a[172:175], v[192:207]
    s_waitcnt vmcnt(23)
    v_mfma_f32_32x32x16_bf16 v[176:191], a[192:195], v[128:131], v[176:191]
    v_mfma_f32_32x32x16_bf16 v[192:207], a[196:199], v[128:131], v[192:207]
    s_waitcnt vmcnt(22)
    v_mfma_f32_32x32x16_bf16 v[176:191], a[200:203], v[132:135], v[176:191]
    v_mfma_f32_32x32x16_bf16 v[192:207], a[204:207], v[132:135], v[192:207]
    s_waitcnt vmcnt(21)
    v_mfma_f32_32x32x16_bf16 v[176:191], a[208:211], v[136:139], v[176:191]
    v_mfma_f32_32x32x16_bf16 v[192:207], a[212:215], v[136:139], v[192:207]
    s_waitcnt vmcnt(20)
    v_mfma_f32_32x32x16_bf16 v[176:191], a[216:219], v[140:143], v[176:191]
    v_mfma_f32_32x32x16_bf16 v[192:207], a[220:223], v[140:143], v[192:207]
    s_barrier
    s_waitcnt vmcnt(12)
    s_cmp_lg_u32 s24, 0
    s_cbranch_scc1 ad_pub_51
    buffer_store_dword v14, v10, s[52:55], s8 offen offset:192
ad_back_52:
    v_and_b32 v6, 31, v0
    v_mul_u32_u24 v11, 272, v6
    v_bfe_u32 v6, v0, 5, 1
    v_lshl_add_u32 v11, v6, 4, v11
    s_mul_i32 s12, s22, 8704
    v_add_u32 v11, s12, v11
    v_lshrrev_b32 v6, 3, v0
    v_mul_u32_u24 v17, 272, v6
    v_and_b32 v7, 7, v0
    v_lshl_add_u32 v17, v7, 5, v17
    s_lshl_b32 s12, s15, 8
    s_add_u32 s12, s12, 155392
    v_lshl_add_u32 v19, v7, 5, s12
    v_and_b32 v18, 15, v6
    v_lshlrev_b32 v18, 7, v18
    v_lshrrev_b32 v6, 4, v6
    v_add_u32 v18, v18, v6
    s_lshl_b32 s12, s3, 1
    v_add_u32 v18, s12, v18
    v_mul_u32_u24 v18, 896, v18
    v_lshl_add_u32 v18, v7, 4, v18
    s_lshl_b32 s12, s15, 7
    v_add_u32 v18, s12, v18
    ds_read_b128 v[104:107], v19
    ds_read_b128 v[108:111], v19 offset:16
    buffer_load_dword v12, v13, s[52:55], s9 offen offset:192 sc1
    v_mfma_f32_32x32x16_bf16 v[144:159], a[224:227], v[112:115], v[144:159]
    v_mfma_f32_32x32x16_bf16 v[160:175], a[228:231], v[112:115], v[160:175]
    v_mfma_f32_32x32x16_bf16 v[144:159], a[232:235], v[116:119], v[144:159]
    v_mfma_f32_32x32x16_bf16 v[160:175], a[236:239], v[116:119], v[160:175]
    v_mfma_f32_32x32x16_bf16 v[144:159], a[240:243], v[120:123], v[144:159]
    v_mfma_f32_32x32x16_bf16 v[160:175], a[244:247], v[120:123], v[160:175]
    v_mfma_f32_32x32x16_bf16 v[144:159], a[248:251], v[124:127], v[144:159]
    v_mfma_f32_32x32x16_bf16 v[160:175], a[252:255], v[124:127], v[160:175]
    s_waitcnt vmcnt(13)
    v_mfma_f32_32x32x16_bf16 v[144:159], a[0:3], v[208:211], v[144:159]
    v_mfma_f32_32x32x16_bf16 v[160:175], a[4:7], v[208:211], v[160:175]
    s_waitcnt vmcnt(12)
    v_mfma_f32_32x32x16_bf16 v[144:159], a[8:11], v[212:215], v[144:159]
    v_mfma_f32_32x32x16_bf16 v[160:175], a[12:15], v[212:215], v[160:175]
ad_again_53:
    s_waitcnt vmcnt(0)
    v_cmp_ne_u32 vcc, v12, v16
    s_nop 4
    s_cbranch_vccnz ad_stub_55
ad_ok_54:
    s_add_u32 s25, s13, 57344
    buffer_load_dwordx4 a[144:147], v4, s[52:55], s25 offen offset:0 sc1
    buffer_load_dwordx4 a[148:151], v4, s[52:55], s25 offen offset:1024 sc1
    s_add_u32 s25, s13, 65536
    buffer_load_dwordx4 a[152:155], v4, s[52:55], s25 offen offset:0 sc1
    buffer_load_dwordx4 a[156:159], v4, s[52:55], s25 offen offset:1024 sc1
    v_mfma_f32_32x32x16_bf16 v[144:159], a[16:19], v[216:219], v[144:159]
    v_mfma_f32_32x32x16_bf16 v[160:175], a[20:23], v[216:219], v[160:175]
    v_mfma_f32_32x32x16_bf16 v[144:159], a[24:27], v[220:223], v[144:159]
    v_mfma_f32_32x32x16_bf16 v[160:175], a[28:31], v[220:223], v[160:175]
    s_add_u32 s25, s13, 73728
    buffer_load_dwordx4 a[160:163], v4, s[52:55], s25 offen offset:0 sc1
    buffer_load_dwordx4 a[164:167], v4, s[52:55], s25 offen offset:1024 sc1
    s_add_u32 s25, s13, 81920
    buffer_load_dwordx4 a[168:171], v4, s[52:55], s25 offen offset:0 sc1
    buffer_load_dwordx4 a[172:175], v4, s[52:55], s25 offen offset:1024 sc1
    v_mfma_f32_32x32x16_bf16 v[176:191], a[224:227], v[224:227], v[176:191]
    v_mfma_f32_32x32x16_bf16 v[192:207], a[228:231], v[224:227], v[192:207]
    v_mfma_f32_32x32x16_bf16 v[176:191], a[232:235], v[228:231], v[176:191]
    v_mfma_f32_32x32x16_bf16 v[192:207], a[236:239], v[228:231], v[192:207]
    s_add_u32 s25, s13, 90112
    buffer_load_dwordx4 v[128:131], v4, s[52:55], s25 offen offset:0 sc1
    buffer_load_dwordx4 v[132:135], v4, s[52:55], s25 offen offset:1024 sc1
    s_add_u32 s25, s13, 98304
    buffer_load_dwordx4 v[136:139], v4, s[52:55], s25 offen offset:0 sc1
    buffer_load_dwordx4 v[140:143], v4, s[52:55], s25 offen offset:1024 sc1
    v_mfma_f32_32x32x16_bf16 v[176:191], a[240:243], v[232:235], v[176:191]
    v_mfma_f32_32x32x16_bf16 v[192:207], a[244:247], v[232:235], v[192:207]
    v_mfma_f32_32x32x16_bf16 v[176:191], a[248:251], v[236:239], v[176:191]
    v_mfma_f32_32x32x16_bf16 v[192:207], a[252:255], v[236:239], v[192:207]
    s_add_u32 s25, s13, 106496
    buffer_load_dwordx4 v[112:115], v4, s[52:55], s25 offen offset:0 sc1
    buffer_load_dwordx4 v[116:119], v4, s[52:55], s25 offen offset:1024 sc1
    s_add_u32 s25, s13, 172032
    buffer_load_dwordx4 v[120:123], v4, s[52:55], s25 offen offset:0 sc1
    buffer_load_dwordx4 v[124:127], v4, s[52:55], s25 offen offset:1024 sc1
    v_mfma_f32_32x32x16_bf16 v[176:191], a[0:3], v[240:243], v[176:191]
    v_mfma_f32_32x32x16_bf16 v[192:207], a[4:7], v[240:243], v[192:207]
    v_mfma_f32_32x32x16_bf16 v[176:191], a[8:11], v[244:247], v[176:191]
    v_mfma_f32_32x32x16_bf16 v[192:207], a[12:15], v[244:247], v[192:207]
    s_add_u32 s25, s13, 180224
    buffer_load_dwordx4 v[208:211], v4, s[52:55], s25 offen offset:0 sc1
    buffer_load_dwordx4 v[212:215], v4, s[52:55], s25 offen offset:1024 sc1
    s_add_u32 s25, s13, 188416
    buffer_load_dwordx4 v[216:219], v4, s[52:55], s25 offen offset:0 sc1
    buffer_load_dwordx4 v[220:223], v4, s[52:55], s25 offen offset:1024 sc1
    v_mfma_f32_32x32x16_bf16 v[176:191], a[16:19], v[248:251], v[176:191]
    v_mfma_f32_32x32x16_bf16 v[192:207], a[20:23], v[248:251], v[192:207]
    v_mfma_f32_32x32x16_bf16 v[176:191], a[24:27], v[252:255], v[176:191]
    v_mfma_f32_32x32x16_bf16 v[192:207], a[28:31], v[252:255], v[192:207]
    s_add_u32 s25, s13, 196608
    buffer_load_dwordx4 v[224:227], v4, s[52:55], s25 offen offset:0 sc1
    buffer_load_dwordx4 v[228:231], v4, s[52:55], s25 offen offset:1024 sc1
    s_add_u32 s25, s13, 204800
    buffer_load_dwordx4 v[232:235], v4, s[52:55], s25 offen offset:0 sc1
    buffer_load_dwordx4 v[236:239], v4, s[52:55], s25 offen offset:1024 sc1
    s_waitcnt vmcnt(23)
    v_mfma_f32_32x32x16_bf16 v[144:159], a[32:35], a[144:147], v[144:159]
    v_mfma_f32_32x32x16_bf16 v[160:175], a[36:39], a[144:147], v[160:175]
    s_waitcnt vmcnt(22)
    v_mfma_f32_32x32x16_bf16 v[144:159], a[40:43], a[148:151], v[144:159]
    v_mfma_f32_32x32x16_bf16 v[160:175], a[44:47], a[148:151], v[160:175]
    s_add_u32 s25, s13, 212992
    buffer_load_dwordx4 v[240:243], v4, s[52:55], s25 offen offset:0 sc1
    buffer_load_dwordx4 v[244:247], v4, s[52:55], s25 offen offset:1024 sc1
    s_add_u32 s25, s13, 221184
    buffer_load_dwordx4 v[248:251], v4, s[52:55], s25 offen offset:0 sc1
    buffer_load_dwordx4 v[252:255], v4, s[52:55], s25 offen offset:1024 sc1
    s_barrier
    buffer_load_dwordx4 v[36:39], v18, s[4:7], 0 offen sc1
    buffer_load_dwordx4 v[40:43], v18, s[4:7], 0 offen offset:1792 sc1
    s_waitcnt vmcnt(27)
    v_mfma_f32_32x32x16_bf16 v[144:159], a[48:51], a[152:155], v[144:159]
    v_mfma_f32_32x32x16_bf16 v[160:175], a[52:55], a[152:155], v[160:175]
    s_waitcnt vmcnt(26)
    v_mfma_f32_32x32x16_bf16 v[144:159], a[56:59], a[156:159], v[144:159]
    v_mfma_f32_32x32x16_bf16 v[160:175], a[60:63], a[156:159], v[160:175]
    s_waitcnt vmcnt(25)
    v_mfma_f32_32x32x16_bf16 v[144:159], a[64:67], a[160:163], v[144:159]
    v_mfma_f32_32x32x16_bf16 v[160:175], a[68:71], a[160:163], v[160:175]
    s_waitcnt vmcnt(24)
    v_mfma_f32_32x32x16_bf16 v[144:159], a[72:75], a[164:167], v[144:159]
    v_mfma_f32_32x32x16_bf16 v[160:175], a[76:79], a[164:167], v[160:175]
    s_waitcnt vmcnt(23)
    v_mfma_f32_32x32x16_bf16 v[144:159], a[80:83], a[168:171], v[144:159]
    v_mfma_f32_32x32x16_bf16 v[160:175], a[84:87], a[168:171], v[160:175]
    s_waitcnt vmcnt(22)
    v_mfma_f32_32x32x16_bf16 v[144:159], a[88:91], a[172:175], v[144:159]
    v_mfma_f32_32x32x16_bf16 v[160:175], a[92:95], a[172:175], v[160:175]
    s_waitcnt vmcnt(21)
    v_mfma_f32_32x32x16_bf16 v[144:159], a[96:99], v[128:131], v[144:159]
    v_mfma_f32_32x32x16_bf16 v[160:175], a[100:103], v[128:131], v[160:175]
    s_waitcnt vmcnt(20)
    v_mfma_f32_32x32x16_bf16 v[144:159], a[104:107], v[132:135], v[144:159]
    v_mfma_f32_32x32x16_bf16 v[160:175], a[108:111], v[132:135], v[160:175]
    s_waitcnt vmcnt(19)
    v_mfma_f32_32x32x16_bf16 v[144:159], a[112:115], v[136:139], v[144:159]
    v_mfma_f32_32x32x16_bf16 v[160:175], a[116:119], v[136:139], v[160:175]
    s_waitcnt vmcnt(18)
    v_mfma_f32_32x32x16_bf16 v[144:159], a[120:123], v[140:143], v[144:159]
    v_mfma_f32_32x32x16_bf16 v[160:175], a[124:127], v[140:143], v[160:175]
    s_waitcnt vmcnt(17)
    v_mfma_f32_32x32x16_bf16 v[144:159], a[128:131], v[112:115], v[144:159]
    v_mfma_f32_32x32x16_bf16 v[160:175], a[132:135], v[112:115], v[160:175]
    s_waitcnt vmcnt(16)
    v_mfma_f32_32x32x16_bf16 v[144:159], a[136:139], v[116:119], v[144:159]
    v_mfma_f32_32x32x16_bf16 v[160:175], a[140:143], v[116:119], v[160:175]
    s_waitcnt vmcnt(15)
    v_mfma_f32_32x32x16_bf16 v[176:191], a[32:35], v[120:123], v[176:191]
    v_mfma_f32_32x32x16_bf16 v[192:207], a[36:39], v[120:123], v[192:207]
    s_waitcnt vmcnt(14)
    v_mfma_f32_32x32x16_bf16 v[176:191], a[40:43], v[124:127], v[176:191]
    v_mfma_f32_32x32x16_bf16 v[192:207], a[44:47], v[124:127], v[192:207]
    s_waitcnt vmcnt(13)
    v_mfma_f32_32x32x16_bf16 v[176:191], a[48:51], v[208:211], v[176:191]
    s_nop 2
    ds_write_b128 v11, v[144:147] offset:0
    ds_write_b128 v11, v[148:151] offset:32
    ds_write_b128 v11, v[152:155] offset:64
    ds_write_b128 v11, v[156:159] offset:96
    v_mfma_f32_32x32x16_bf16 v[192:207], a[52:55], v[208:211], v[192:207]
    ds_write_b128 v11, v[160:163] offset:128
    ds_write_b128 v11, v[164:167] offset:160
    ds_write_b128 v11, v[168:171] offset:192
    ds_write_b128 v11, v[172:175] offset:224
    s_waitcnt vmcnt(12)
    v_mfma_f32_32x32x16_bf16 v[176:191], a[56:59], v[212:215], v[176:191]
    v_mfma_f32_32x32x16_bf16 v[192:207], a[60:63], v[212:215], v[192:207]
    s_waitcnt lgkmcnt(0)
    s_barrier
    s_waitcnt vmcnt(11)
    v_mfma_f32_32x32x16_bf16 v[176:191], a[64:67], v[216:219], v[176:191]
    ds_read_b128 v[80:83], v17 offset:0
    ds_read_b128 v[84:87], v17 offset:16
    ds_read_b128 v[88:91], v17 offset:8704
    ds_read_b128 v[92:95], v17 offset:8720
    v_mfma_f32_32x32x16_bf16 v[192:207], a[68:71], v[216:219], v[192:207]
    ds_read_b128 v[20:23], v17 offset:17408
    ds_read_b128 v[24:27], v17 offset:17424
    ds_read_b128 v[28:31], v17 offset:26112
    ds_read_b128 v[32:35], v17 offset:26128
    s_waitcnt vmcnt(10)
    v_mfma_f32_32x32x16_bf16 v[176:191], a[72:75], v[220:223], v[176:191]
    s_waitcnt lgkmcnt(5)
    v_add_f32 v80, v80, v88
    v_add_f32 v81, v81, v89
    v_add_f32 v82, v82, v90
    v_add_f32 v83, v83, v91
    v_mfma_f32_32x32x16_bf16 v[192:207], a[76:79], v[220:223], v[192:207]
    s_waitcnt lgkmcnt(4)
    v_add_f32 v84, v84, v92
    v_add_f32 v85, v85, v93
    v_add_f32 v86, v86, v94
    v_add_f32 v87, v87, v95
    s_waitcnt vmcnt(9)
    v_mfma_f32_32x32x16_bf16 v[176:191], a[80:83], v[224:227], v[176:191]
    s_waitcnt lgkmcnt(1)
    v_add_f32 v20, v20, v28
    v_add_f32 v21, v21, v29
    v_add_f32 v22, v22, v30
    v_add_f32 v23, v23, v31
    v_mfma_f32_32x32x16_bf16 v[192:207], a[84:87], v[224:227], v[192:207]
    s_waitcnt lgkmcnt(0)
    v_add_f32 v24, v24, v32
    v_add_f32 v25, v25, v33
    v_add_f32 v26, v26, v34
    v_add_f32 v27, v27, v35
    s_waitcnt vmcnt(8)
    v_mfma_f32_32x32x16_bf16 v[176:191], a[88:91], v[228:231], v[176:191]
    v_add_f32 v80, v80, v20
    v_add_f32 v81, v81, v21
    v_add_f32 v82, v82, v22
    v_add_f32 v83, v83, v23
    v_mfma_f32_32x32x16_bf16 v[192:207], a[92:95], v[228:231], v[192:207]
    v_add_f32 v84, v84, v24
    v_add_f32 v85, v85, v25
    v_add_f32 v86, v86, v26
    v_add_f32 v87, v87, v27
    s_waitcnt vmcnt(7)
    v_mfma_f32_32x32x16_bf16 v[176:191], a[96:99], v[232:235], v[176:191]
    s_waitcnt vmcnt(1)
    v_lshlrev_b32 v88, 16, v36
    v_and_b32 v89, 0xffff0000, v36
    v_lshlrev_b32 v90, 16, v37
    v_and_b32 v91, 0xffff0000, v37
    v_mfma_f32_32x32x16_bf16 v[176:191], a[104:107], v[236:239], v[176:191]
    v_lshlrev_b32 v92, 16, v38
    v_and_b32 v93, 0xffff0000, v38
    v_lshlrev_b32 v94, 16, v39
    v_and_b32 v95, 0xffff0000, v39
    v_mfma_f32_32x32x16_bf16 v[176:191], a[112:115], v[240:243], v[176:191]
    v_fmac_f32 v88, v104, v80
    v_fmac_f32 v89, v105, v81
    v_fmac_f32 v90, v106, v82
    v_fmac_f32 v91, v107, v83
    v_mfma_f32_32x32x16_bf16 v[176:191], a[120:123], v[244:247], v[176:191]
    v_fmac_f32 v92, v108, v84
    v_fmac_f32 v93, v109, v85
    v_fmac_f32 v94, v110, v86
    v_fmac_f32 v95, v111, v87
    v_mfma_f32_32x32x16_bf16 v[176:191], a[128:131], v[248:251], v[176:191]
    v_cvt_pk_bf16_f32 v20, v88, v89
    v_cvt_pk_bf16_f32 v21, v90, v91
    v_cvt_pk_bf16_f32 v22, v92, v93
    v_cvt_pk_bf16_f32 v23, v94, v95
    v_mfma_f32_32x32x16_bf16 v[176:191], a[136:139], v[252:255], v[176:191]
    buffer_store_dwordx4 v[20:23], v18, s[4:7], 0 offen offset:0 nt
    v_mfma_f32_32x32x16_bf16 v[192:207], a[100:103], v[232:235], v[192:207]
    v_mfma_f32_32x32x16_bf16 v[192:207], a[108:111], v[236:239], v[192:207]
    s_nop 8
    ds_write_b128 v11, v[176:179] offset:34816
    ds_write_b128 v11, v[180:183] offset:34848
    v_mfma_f32_32x32x16_bf16 v[192:207], a[116:119], v[240:243], v[192:207]
    ds_write_b128 v11, v[184:187] offset:34880
    ds_write_b128 v11, v[188:191] offset:34912
    v_mfma_f32_32x32x16_bf16 v[192:207], a[124:127], v[244:247], v[192:207]
    v_mfma_f32_32x32x16_bf16 v[192:207], a[132:135], v[248:251], v[192:207]
    v_mfma_f32_32x32x16_bf16 v[192:207], a[140:143], v[252:255], v[192:207]
    s_nop 11
    ds_write_b128 v11, v[192:195] offset:34944
    ds_write_b128 v11, v[196:199] offset:34976
    ds_write_b128 v11, v[200:203] offset:35008
    ds_write_b128 v11, v[204:207] offset:35040
    s_waitcnt lgkmcnt(0)
    s_barrier
    ds_read_b128 v[80:83], v17 offset:34816
    ds_read_b128 v[84:87], v17 offset:34832
    ds_read_b128 v[88:91], v17 offset:43520
    ds_read_b128 v[92:95], v17 offset:43536
    ds_read_b128 v[20:23], v17 offset:52224
    ds_read_b128 v[24:27], v17 offset:52240
    ds_read_b128 v[28:31], v17 offset:60928
    ds_read_b128 v[32:35], v17 offset:60944
    s_waitcnt lgkmcnt(5)
    v_add_f32 v80, v80, v88
    v_add_f32 v81, v81, v89
    v_add_f32 v82, v82, v90
    v_add_f32 v83, v83, v91
    s_waitcnt lgkmcnt(4)
    v_add_f32 v84, v84, v92
    v_add_f32 v85, v85, v93
    v_add_f32 v86, v86, v94
    v_add_f32 v87, v87, v95
    s_waitcnt lgkmcnt(1)
    v_add_f32 v20, v20, v28
    v_add_f32 v21, v21, v29
    v_add_f32 v22, v22, v30
    v_add_f32 v23, v23, v31
    s_waitcnt lgkmcnt(0)
    v_add_f32 v24, v24, v32
    v_add_f32 v25, v25, v33
    v_add_f32 v26, v26, v34
    v_add_f32 v27, v27, v35
    v_add_f32 v80, v80, v20
    v_add_f32 v81, v81, v21
    v_add_f32 v82, v82, v22
    v_add_f32 v83, v83, v23
    v_add_f32 v84, v84, v24
    v_add_f32 v85, v85, v25
    v_add_f32 v86, v86, v26
    v_add_f32 v87, v87, v27
    s_waitcnt vmcnt(1)
    v_lshlrev_b32 v88, 16, v40
    v_and_b32 v89, 0xffff0000, v40
    v_lshlrev_b32 v90, 16, v41
    v_and_b32 v91, 0xffff0000, v41
    v_lshlrev_b32 v92, 16, v42
    v_and_b32 v93, 0xffff0000, v42
    v_lshlrev_b32 v94, 16, v43
    v_and_b32 v95, 0xffff0000, v43
    v_fmac_f32 v88, v104, v80
    v_fmac_f32 v89, v105, v81
    v_fmac_f32 v90, v106, v82
    v_fmac_f32 v91, v107, v83
    v_fmac_f32 v92, v108, v84
    v_fmac_f32 v93, v109, v85
    v_fmac_f32 v94, v110, v86
    v_fmac_f32 v95, v111, v87
    v_cvt_pk_bf16_f32 v20, v88, v89
    v_cvt_pk_bf16_f32 v21, v90, v91
    v_cvt_pk_bf16_f32 v22, v92, v93
    v_cvt_pk_bf16_f32 v23, v94, v95
    buffer_store_dwordx4 v[20:23], v18, s[4:7], 0 offen offset:1792 nt
    s_cmp_lg_u32 s2, 0
    s_cbranch_scc1 ad_end_1
    v_cmp_eq_u32 vcc, 0, v0
    s_nop 1
    v_cndmask_b32 v6, v8, v0, vcc
    buffer_store_dword v14, v6, s[52:55], 0 offen offset:0
ad_end_1:
ad_rend_2:
    s_endpgm
ad_pub_42:
    buffer_store_dword v14, v10, s[52:55], s39 offen offset:0 sc1
    s_branch ad_back_43
ad_pub_46:
    buffer_store_dword v14, v10, s[52:55], s8 offen offset:64 sc1
    s_branch ad_back_47
ad_stub_50:
    s_sub_u32 s28, s28, 1
    s_cmp_eq_u32 s28, 0
    s_cselect_b32 s28, 1, s28
    s_cbranch_scc1 ad_ok_49
    s_sleep 1
    buffer_load_dword v12, v13, s[52:55], s9 offen offset:64 sc1
    s_waitcnt vmcnt(0)
    s_branch ad_again_48
ad_pub_51:
    buffer_store_dword v14, v10, s[52:55], s8 offen offset:192 sc1
    s_branch ad_back_52
ad_stub_55:
    s_sub_u32 s28, s28, 1
    s_cmp_eq_u32 s28, 0
    s_cselect_b32 s28, 1, s28
    s_cbranch_scc1 ad_ok_54
    s_sleep 1
    buffer_load_dword v12, v13, s[52:55], s9 offen offset:192 sc1
    s_waitcnt vmcnt(0)
    s_branch ad_again_53
ad_last_3:
    s_endpgm
.section .rodata,"a"
.p2align 6
.amdhsa_kernel adaLN_cond__spectral_gfnet__dense_activation_silu__prompt_kernel
  .amdhsa_next_free_vgpr 512
  .amdhsa_next_free_sgpr 91
  .amdhsa_accum_offset 256
  .amdhsa_group_segment_fixed_size 0
  .amdhsa_kernarg_size 88
  .amdhsa_user_sgpr_count 2
  .amdhsa_user_sgpr_kernarg_segment_ptr 1
  .amdhsa_system_sgpr_workgroup_id_x 1
  .amdhsa_float_denorm_mode_32 3
.end_amdhsa_kernel
```
